```python
import torch

def _softmax(x, axis=-1):
    return torch.softmax(x, dim=axis)
def _gelu(x):
    return torch.nn.functional.gelu(x, approximate="tanh")
def _silu(x):
    return torch.nn.functional.silu(x)
def _sigmoid(x):
    return torch.sigmoid(x)
def _layernorm(x, axis=-1, eps=1e-5):
    m = x.mean(dim=axis, keepdim=True)
    v = x.var(dim=axis, keepdim=True, unbiased=False)
    return (x - m) / torch.sqrt(v + eps)
def _scatter_add(tgt, idx, src, axis=0):
    return tgt.clone().index_add_(axis, idx, src)
def _segment_sum(src, seg, n):
    out = torch.zeros((n,) + src.shape[1:], dtype=src.dtype)
    return out.index_add_(0, seg, src)
def _pad(x, pw):
    flat = tuple(v for pair in reversed(pw) for v in pair)
    return torch.nn.functional.pad(x, flat)

kernel_name = 'standalone__mha_block_cached__near_ridge'

def setup_inputs():

    _w = (lambda a: (lambda t: t.to(torch.bfloat16) if t.is_floating_point() else t)(torch.as_tensor(a)))
    B, Sq, D = 8, 96, 1024
    H, Sk, Dh = 32, 512, 128
    return {
        "x": _w((lambda *s: torch.randn(*s, dtype=torch.bfloat16) * 0.8)(B, Sq, D)),
        "k_cache": _w((lambda *s: torch.randn(*s, dtype=torch.bfloat16) * 0.8)(B, H, Sk, Dh)),
        "v_cache": _w((lambda *s: torch.randn(*s, dtype=torch.bfloat16) * 0.05)(B, H, Sk, Dh)),
        "wq": _w((lambda *s: torch.randn(*s, dtype=torch.bfloat16) * 0.8)(D, H * Dh) * (D ** -0.5)),
        "wo": _w((lambda *s: torch.randn(*s, dtype=torch.bfloat16) * 0.05)(H * Dh, D) * ((H * Dh) ** -0.5)),
    }

def reference(x, k_cache, v_cache, wq, wo):
    B, Sq, D = x.shape
    H, Dh = 32, 128
    q = (lambda x, *d: x.permute(*d))((x @ wq).reshape(B, Sq, H, Dh), 0, 2, 1, 3)
    scores = torch.einsum("bhqd,bhkd->bhqk", q, k_cache) * (Dh ** -0.5)
    p = _softmax(scores, axis=-1)
    o = torch.einsum("bhqk,bhkd->bhqd", p, v_cache)
    return (lambda x, *d: x.permute(*d))(o, 0, 2, 1, 3).reshape(B, Sq, H * Dh) @ wo
```

```asm
; @launch kernel=attn_kernel grid=(256,1,1) block=(256,1,1) lds=163840
; @launch kernel=oproj_kernel grid=(256,1,1) block=(256,1,1) lds=131072
.amdgcn_target "amdgcn-amd-amdhsa--gfx950"
.text
.globl attn_kernel
.p2align 8
.type attn_kernel,@function
attn_kernel:
    s_cmp_ge_u32 s2, 256
    s_cbranch_scc1 L_k1end_1
    s_load_dwordx8 s[4:11], s[0:1], 0
    s_load_dwordx2 s[12:13], s[0:1], 56
    v_lshrrev_b32 v44, 6, v0
    v_and_b32 v1, 63, v0
    s_and_b32 s19, s2, 7
    v_readfirstlane_b32 s16, v44
    s_lshr_b32 s3, s2, 3
    s_and_b32 s17, s3, 7
    s_lshr_b32 s18, s3, 3
    s_lshl_b32 s72, s19, 2
    s_add_u32 s18, s18, s72
    s_mul_i32 s14, s17, 2
    s_lshr_b32 s15, s3, 3
    s_mul_i32 s15, s15, 5
    s_add_u32 s14, s14, s15
    s_and_b32 s14, s14, 15
    s_lshl_b32 s15, s14, 19
    s_lshl_b32 s14, s14, 7
    s_cmp_eq_u32 s16, 3
    s_cbranch_scc1 L_k1load_2
    v_lshrrev_b32 v44, 3, v1
    v_lshlrev_b32 v44, 11, v44
    v_lshrrev_b32 v45, 4, v1
    v_and_b32 v46, 7, v1
    v_xor_b32 v46, v46, v45
    v_lshl_add_u32 v2, v46, 4, v44
    v_xor_b32 v3, 64, v2
    v_add_u32 v4, 30720, v2
    v_add_u32 v5, 46080, v3
    v_add_u32 v3, 15360, v3
    v_and_b32 v46, 15, v1
    v_lshlrev_b32 v47, 2, v45
    v_xor_b32 v46, v46, v47
    v_lshlrev_b32 v46, 4, v46
    v_lshl_add_u32 v46, v45, 13, v46
    s_lshl_b32 s72, s16, 15
    v_add_u32 v6, s72, v46
    v_add_u32 v7, 95232, v6
    v_add_u32 v8, 196608, v6
    v_add_u32 v9, 291840, v6
    v_add_u32 v10, 393216, v6
    v_add_u32 v11, 488448, v6
    s_lshl_b32 s78, s16, 12
    s_lshl_b32 s79, s16, 10
    s_mul_i32 s72, s17, 96
    s_lshl_b32 s73, s16, 5
    s_add_u32 s72, s72, s73
    s_lshl_b32 s72, s72, 11
    s_lshl_b32 s73, s18, 8
    s_waitcnt lgkmcnt(0)
    s_add_u32 s20, s4, s72
    s_addc_u32 s21, s5, 0
    s_mov_b32 s22, 65536
    s_mov_b32 s23, 0x00020000
    s_add_u32 s24, s10, s73
    s_addc_u32 s25, s11, 0
    s_sub_u32 s26, 8388608, s73
    s_mov_b32 s27, 0x00020000
    s_add_u32 m0, s79, 135168
    s_add_u32 s77, s15, 0
    s_and_b32 s77, s77, 8388607
    buffer_load_dwordx4 v6, s[24:27], s77 offen offset:0 lds
    buffer_load_dwordx4 v7, s[24:27], s77 offen offset:3072 lds
    s_add_u32 m0, s79, 141312
    s_nop 0
    buffer_load_dwordx4 v8, s[24:27], s77 offen offset:0 lds
    buffer_load_dwordx4 v9, s[24:27], s77 offen offset:3072 lds
    s_add_u32 m0, s79, 147456
    s_nop 0
    buffer_load_dwordx4 v10, s[24:27], s77 offen offset:0 lds
    s_cmp_lg_u32 s16, 0
    s_cbranch_scc1 L_w0_8
    buffer_load_dwordx4 v11, s[24:27], s77 offen offset:3072 lds
L_w0_8:
    s_add_u32 m0, s78, 151552
    s_add_u32 s76, s14, 0
    s_and_b32 s76, s76, 2047
    buffer_load_dwordx4 v2, s[20:23], s76 offen offset:0 lds
    buffer_load_dwordx4 v3, s[20:23], s76 offen offset:1024 lds
    buffer_load_dwordx4 v4, s[20:23], s76 offen offset:2048 lds
    buffer_load_dwordx4 v5, s[20:23], s76 offen offset:3072 lds
    s_add_u32 m0, s79, 77824
    s_add_u32 s77, s15, 524288
    s_and_b32 s77, s77, 8388607
    buffer_load_dwordx4 v6, s[24:27], s77 offen offset:0 lds
    buffer_load_dwordx4 v7, s[24:27], s77 offen offset:3072 lds
    s_add_u32 m0, s79, 83968
    s_nop 0
    buffer_load_dwordx4 v8, s[24:27], s77 offen offset:0 lds
    buffer_load_dwordx4 v9, s[24:27], s77 offen offset:3072 lds
    s_add_u32 m0, s79, 90112
    s_nop 0
    buffer_load_dwordx4 v10, s[24:27], s77 offen offset:0 lds
    s_cmp_lg_u32 s16, 0
    s_cbranch_scc1 L_w0_9
    buffer_load_dwordx4 v11, s[24:27], s77 offen offset:3072 lds
L_w0_9:
    s_add_u32 m0, s78, 94208
    s_add_u32 s76, s14, 128
    s_and_b32 s76, s76, 2047
    buffer_load_dwordx4 v2, s[20:23], s76 offen offset:0 lds
    buffer_load_dwordx4 v3, s[20:23], s76 offen offset:1024 lds
    buffer_load_dwordx4 v4, s[20:23], s76 offen offset:2048 lds
    buffer_load_dwordx4 v5, s[20:23], s76 offen offset:3072 lds
    s_add_u32 m0, s79, 106496
    s_add_u32 s77, s15, 1048576
    s_and_b32 s77, s77, 8388607
    buffer_load_dwordx4 v6, s[24:27], s77 offen offset:0 lds
    buffer_load_dwordx4 v7, s[24:27], s77 offen offset:3072 lds
    s_add_u32 m0, s79, 112640
    s_nop 0
    buffer_load_dwordx4 v8, s[24:27], s77 offen offset:0 lds
    buffer_load_dwordx4 v9, s[24:27], s77 offen offset:3072 lds
    s_add_u32 m0, s79, 118784
    s_nop 0
    buffer_load_dwordx4 v10, s[24:27], s77 offen offset:0 lds
    s_cmp_lg_u32 s16, 0
    s_cbranch_scc1 L_w0_10
    buffer_load_dwordx4 v11, s[24:27], s77 offen offset:3072 lds
L_w0_10:
    s_add_u32 m0, s78, 122880
    s_add_u32 s76, s14, 256
    s_and_b32 s76, s76, 2047
    buffer_load_dwordx4 v2, s[20:23], s76 offen offset:0 lds
    buffer_load_dwordx4 v3, s[20:23], s76 offen offset:1024 lds
    buffer_load_dwordx4 v4, s[20:23], s76 offen offset:2048 lds
    buffer_load_dwordx4 v5, s[20:23], s76 offen offset:3072 lds
    v_and_b32 v44, 31, v1
    v_lshrrev_b32 v45, 5, v1
    v_bfe_u32 v46, v1, 1, 3
    v_xor_b32 v46, v46, v45
    v_lshlrev_b32 v46, 4, v46
    v_lshl_add_u32 v46, v44, 7, v46
    s_add_u32 s72, s78, 94208
    v_add_u32 v12, s72, v46
    v_xor_b32 v13, 32, v12
    v_xor_b32 v14, 64, v12
    v_xor_b32 v15, 96, v12
    v_and_b32 v46, 15, v1
    v_xor_b32 v46, v46, v45
    v_lshlrev_b32 v46, 4, v46
    v_lshl_add_u32 v24, v44, 8, v46
    v_xor_b32 v25, 32, v24
    v_xor_b32 v26, 64, v24
    v_xor_b32 v27, 96, v24
    v_xor_b32 v28, 128, v24
    v_xor_b32 v29, 160, v24
    v_xor_b32 v30, 192, v24
    v_xor_b32 v31, 224, v24
    v_bfe_u32 v44, v1, 2, 2
    v_mul_u32_u24 v46, 320, v44
    v_bfe_u32 v47, v1, 4, 1
    v_lshl_add_u32 v46, v47, 5, v46
    v_and_b32 v47, 1, v1
    v_lshl_add_u32 v46, v47, 4, v46
    v_bfe_u32 v47, v1, 1, 1
    v_lshl_add_u32 v46, v47, 3, v46
    v_lshl_add_u32 v16, v45, 11, v46
    v_add_u32 v16, 77824, v16
    v_lshl_add_u32 v32, v45, 10, v46
    v_xor_b32 v17, 64, v16
    v_xor_b32 v33, 64, v32
    v_xor_b32 v18, 128, v16
    v_xor_b32 v34, 128, v32
    v_xor_b32 v19, 192, v16
    v_xor_b32 v35, 192, v32
    v_add_u32 v20, 57344, v16
    v_add_u32 v36, 65536, v32
    v_add_u32 v40, 131072, v32
    v_add_u32 v21, 57344, v17
    v_add_u32 v37, 65536, v33
    v_add_u32 v41, 131072, v33
    v_add_u32 v22, 57344, v18
    v_add_u32 v38, 65536, v34
    v_add_u32 v42, 131072, v34
    v_add_u32 v23, 57344, v19
    v_add_u32 v39, 65536, v35
    v_add_u32 v43, 131072, v35
    s_mul_i32 s72, s17, 6
    s_lshl_b32 s73, s16, 1
    s_add_u32 s72, s72, s73
    s_mul_i32 s73, s72, 43
    s_lshr_b32 s73, s73, 7
    s_mul_i32 s74, s73, 3
    s_sub_u32 s74, s72, s74
    s_mul_i32 s73, s73, 393216
    s_lshl_b32 s74, s74, 10
    s_add_u32 s73, s73, s74
    v_mov_b32 v46, s73
    s_add_u32 s72, s72, 1
    s_mul_i32 s73, s72, 43
    s_lshr_b32 s73, s73, 7
    s_mul_i32 s74, s73, 3
    s_sub_u32 s74, s72, s74
    s_mul_i32 s73, s73, 393216
    s_lshl_b32 s74, s74, 10
    s_add_u32 s73, s73, s74
    v_mov_b32 v47, s73
    v_and_b32 v44, 16, v1
    v_cmp_ne_u32 vcc, 0, v44
    v_and_b32 v44, 15, v1
    v_lshl_add_u32 v44, v45, 4, v44
    v_cndmask_b32 v46, v46, v47, vcc
    v_lshl_add_u32 v63, v44, 4, v46
    s_mul_i32 s72, s18, 12288
    s_add_u32 s28, s12, s72
    s_addc_u32 s29, s13, 0
    s_sub_u32 s30, 6291456, s72
    s_mov_b32 s31, 0x00020000
    s_mov_b32 s82, 1040356334
    s_mov_b32 s83, 1040356334
    s_mov_b32 s81, 0xffff0000
    v_mov_b32 v56, 0xff800000
    v_mov_b32 v57, 0xff800000
    v_mov_b32 v60, 0x3f803f80
    v_accvgpr_write_b32 a88, v60
    v_accvgpr_write_b32 a89, v60
    v_accvgpr_write_b32 a90, v60
    v_accvgpr_write_b32 a91, v60
    s_cmp_eq_u32 s16, 0
    s_cbranch_scc1 L_wq_11
    s_waitcnt vmcnt(18)
L_wq_11:
    s_waitcnt vmcnt(20)
    s_barrier
    ds_read_b128 a[64:67], v12 offset:57344
    ds_read_b64_tr_b16 a[0:1], v20 offset:0
    ds_read_b64_tr_b16 a[2:3], v20 offset:1024
    ds_read_b64_tr_b16 a[4:5], v21 offset:0
    ds_read_b64_tr_b16 a[6:7], v21 offset:1024
    ds_read_b64_tr_b16 a[8:9], v22 offset:0
    ds_read_b64_tr_b16 a[10:11], v22 offset:1024
    ds_read_b64_tr_b16 a[12:13], v23 offset:0
    ds_read_b64_tr_b16 a[14:15], v23 offset:1024
    s_waitcnt lgkmcnt(6)
    v_mfma_f32_32x32x16_bf16 v[128:143], a[0:3], a[64:67], 0
    ds_read_b128 a[68:71], v13 offset:57344
    ds_read_b64_tr_b16 a[16:17], v20 offset:4096
    ds_read_b64_tr_b16 a[18:19], v20 offset:5120
    s_waitcnt lgkmcnt(7)
    v_mfma_f32_32x32x16_bf16 v[144:159], a[4:7], a[64:67], 0
    ds_read_b64_tr_b16 a[20:21], v21 offset:4096
    ds_read_b64_tr_b16 a[22:23], v21 offset:5120
    ds_read_b64_tr_b16 a[24:25], v22 offset:4096
    s_waitcnt lgkmcnt(8)
    v_mfma_f32_32x32x16_bf16 v[160:175], a[8:11], a[64:67], 0
    ds_read_b64_tr_b16 a[26:27], v22 offset:5120
    ds_read_b64_tr_b16 a[28:29], v23 offset:4096
    ds_read_b64_tr_b16 a[30:31], v23 offset:5120
    s_waitcnt lgkmcnt(9)
    v_mfma_f32_32x32x16_bf16 v[176:191], a[12:15], a[64:67], 0
    s_waitcnt lgkmcnt(6)
    v_mfma_f32_32x32x16_bf16 v[128:143], a[16:19], a[68:71], v[128:143]
    ds_read_b128 a[64:67], v14 offset:57344
    ds_read_b64_tr_b16 a[0:1], v20 offset:8192
    ds_read_b64_tr_b16 a[2:3], v20 offset:9216
    s_waitcnt lgkmcnt(7)
    v_mfma_f32_32x32x16_bf16 v[144:159], a[20:23], a[68:71], v[144:159]
    ds_read_b64_tr_b16 a[4:5], v21 offset:8192
    ds_read_b64_tr_b16 a[6:7], v21 offset:9216
    ds_read_b64_tr_b16 a[8:9], v22 offset:8192
    s_waitcnt lgkmcnt(8)
    v_mfma_f32_32x32x16_bf16 v[160:175], a[24:27], a[68:71], v[160:175]
    ds_read_b64_tr_b16 a[10:11], v22 offset:9216
    ds_read_b64_tr_b16 a[12:13], v23 offset:8192
    ds_read_b64_tr_b16 a[14:15], v23 offset:9216
    s_waitcnt lgkmcnt(9)
    v_mfma_f32_32x32x16_bf16 v[176:191], a[28:31], a[68:71], v[176:191]
    s_waitcnt lgkmcnt(6)
    v_mfma_f32_32x32x16_bf16 v[128:143], a[0:3], a[64:67], v[128:143]
    ds_read_b128 a[68:71], v15 offset:57344
    ds_read_b64_tr_b16 a[16:17], v20 offset:12288
    ds_read_b64_tr_b16 a[18:19], v20 offset:13312
    s_waitcnt lgkmcnt(7)
    v_mfma_f32_32x32x16_bf16 v[144:159], a[4:7], a[64:67], v[144:159]
    ds_read_b64_tr_b16 a[20:21], v21 offset:12288
    ds_read_b64_tr_b16 a[22:23], v21 offset:13312
    ds_read_b64_tr_b16 a[24:25], v22 offset:12288
    s_waitcnt lgkmcnt(8)
    v_mfma_f32_32x32x16_bf16 v[160:175], a[8:11], a[64:67], v[160:175]
    ds_read_b64_tr_b16 a[26:27], v22 offset:13312
    ds_read_b64_tr_b16 a[28:29], v23 offset:12288
    ds_read_b64_tr_b16 a[30:31], v23 offset:13312
    s_waitcnt lgkmcnt(9)
    v_mfma_f32_32x32x16_bf16 v[176:191], a[12:15], a[64:67], v[176:191]
    s_waitcnt lgkmcnt(0)
    v_mfma_f32_32x32x16_bf16 v[128:143], a[16:19], a[68:71], v[128:143]
    s_cmp_eq_u32 s16, 0
    s_cbranch_scc1 L_wq_12
    s_waitcnt vmcnt(9)
L_wq_12:
    s_waitcnt vmcnt(10)
    s_barrier
    ds_read_b128 a[64:67], v12 offset:0
    ds_read_b64_tr_b16 a[0:1], v16 offset:0
    ds_read_b64_tr_b16 a[2:3], v16 offset:1024
    v_mfma_f32_32x32x16_bf16 v[144:159], a[20:23], a[68:71], v[144:159]
    s_add_u32 m0, s79, 135168
    s_add_u32 s77, s15, 1572864
    s_and_b32 s77, s77, 8388607
    buffer_load_dwordx4 v6, s[24:27], s77 offen offset:0 lds
    ds_read_b64_tr_b16 a[4:5], v17 offset:0
    ds_read_b64_tr_b16 a[6:7], v17 offset:1024
    ds_read_b64_tr_b16 a[8:9], v18 offset:0
    v_mfma_f32_32x32x16_bf16 v[160:175], a[24:27], a[68:71], v[160:175]
    buffer_load_dwordx4 v7, s[24:27], s77 offen offset:3072 lds
    ds_read_b64_tr_b16 a[10:11], v18 offset:1024
    ds_read_b64_tr_b16 a[12:13], v19 offset:0
    ds_read_b64_tr_b16 a[14:15], v19 offset:1024
    v_mfma_f32_32x32x16_bf16 v[176:191], a[28:31], a[68:71], v[176:191]
    s_add_u32 m0, s79, 141312
    s_nop 0
    buffer_load_dwordx4 v8, s[24:27], s77 offen offset:0 lds
    s_waitcnt lgkmcnt(6)
    v_mfma_f32_32x32x16_bf16 v[128:143], a[0:3], a[64:67], v[128:143]
    ds_read_b128 a[68:71], v13 offset:0
    ds_read_b64_tr_b16 a[16:17], v16 offset:4096
    ds_read_b64_tr_b16 a[18:19], v16 offset:5120
    buffer_load_dwordx4 v9, s[24:27], s77 offen offset:3072 lds
    s_waitcnt lgkmcnt(7)
    v_mfma_f32_32x32x16_bf16 v[144:159], a[4:7], a[64:67], v[144:159]
    ds_read_b64_tr_b16 a[20:21], v17 offset:4096
    ds_read_b64_tr_b16 a[22:23], v17 offset:5120
    ds_read_b64_tr_b16 a[24:25], v18 offset:4096
    s_add_u32 m0, s79, 147456
    s_nop 0
    buffer_load_dwordx4 v10, s[24:27], s77 offen offset:0 lds
    s_waitcnt lgkmcnt(8)
    v_mfma_f32_32x32x16_bf16 v[160:175], a[8:11], a[64:67], v[160:175]
    ds_read_b64_tr_b16 a[26:27], v18 offset:5120
    ds_read_b64_tr_b16 a[28:29], v19 offset:4096
    ds_read_b64_tr_b16 a[30:31], v19 offset:5120
    s_cmp_lg_u32 s16, 0
    s_cbranch_scc1 L_w0_13
    buffer_load_dwordx4 v11, s[24:27], s77 offen offset:3072 lds
L_w0_13:
    s_waitcnt lgkmcnt(9)
    v_mfma_f32_32x32x16_bf16 v[176:191], a[12:15], a[64:67], v[176:191]
    s_add_u32 m0, s78, 151552
    s_add_u32 s76, s14, 384
    s_and_b32 s76, s76, 2047
    buffer_load_dwordx4 v2, s[20:23], s76 offen offset:0 lds
    s_waitcnt lgkmcnt(6)
    v_mfma_f32_32x32x16_bf16 v[128:143], a[16:19], a[68:71], v[128:143]
    ds_read_b128 a[64:67], v14 offset:0
    ds_read_b64_tr_b16 a[0:1], v16 offset:8192
    ds_read_b64_tr_b16 a[2:3], v16 offset:9216
    buffer_load_dwordx4 v3, s[20:23], s76 offen offset:1024 lds
    s_waitcnt lgkmcnt(7)
    v_mfma_f32_32x32x16_bf16 v[144:159], a[20:23], a[68:71], v[144:159]
    ds_read_b64_tr_b16 a[4:5], v17 offset:8192
    ds_read_b64_tr_b16 a[6:7], v17 offset:9216
    ds_read_b64_tr_b16 a[8:9], v18 offset:8192
    buffer_load_dwordx4 v4, s[20:23], s76 offen offset:2048 lds
    s_waitcnt lgkmcnt(8)
    v_mfma_f32_32x32x16_bf16 v[160:175], a[24:27], a[68:71], v[160:175]
    ds_read_b64_tr_b16 a[10:11], v18 offset:9216
    ds_read_b64_tr_b16 a[12:13], v19 offset:8192
    ds_read_b64_tr_b16 a[14:15], v19 offset:9216
    buffer_load_dwordx4 v5, s[20:23], s76 offen offset:3072 lds
    s_waitcnt lgkmcnt(9)
    v_mfma_f32_32x32x16_bf16 v[176:191], a[28:31], a[68:71], v[176:191]
    s_waitcnt lgkmcnt(6)
    v_mfma_f32_32x32x16_bf16 v[128:143], a[0:3], a[64:67], v[128:143]
    ds_read_b128 a[68:71], v15 offset:0
    ds_read_b64_tr_b16 a[16:17], v16 offset:12288
    ds_read_b64_tr_b16 a[18:19], v16 offset:13312
    s_waitcnt lgkmcnt(7)
    v_mfma_f32_32x32x16_bf16 v[144:159], a[4:7], a[64:67], v[144:159]
    ds_read_b64_tr_b16 a[20:21], v17 offset:12288
    ds_read_b64_tr_b16 a[22:23], v17 offset:13312
    ds_read_b64_tr_b16 a[24:25], v18 offset:12288
    s_waitcnt lgkmcnt(8)
    v_mfma_f32_32x32x16_bf16 v[160:175], a[8:11], a[64:67], v[160:175]
    ds_read_b64_tr_b16 a[26:27], v18 offset:13312
    ds_read_b64_tr_b16 a[28:29], v19 offset:12288
    ds_read_b64_tr_b16 a[30:31], v19 offset:13312
    s_waitcnt lgkmcnt(9)
    v_mfma_f32_32x32x16_bf16 v[176:191], a[12:15], a[64:67], v[176:191]
    s_waitcnt lgkmcnt(0)
    v_mfma_f32_32x32x16_bf16 v[128:143], a[16:19], a[68:71], v[128:143]
    s_cmp_eq_u32 s16, 0
    s_cbranch_scc1 L_wq_14
    s_waitcnt vmcnt(9)
L_wq_14:
    s_waitcnt vmcnt(10)
    s_barrier
    ds_read_b128 a[64:67], v12 offset:28672
    ds_read_b64_tr_b16 a[0:1], v16 offset:28672
    ds_read_b64_tr_b16 a[2:3], v16 offset:29696
    v_mfma_f32_32x32x16_bf16 v[144:159], a[20:23], a[68:71], v[144:159]
    s_add_u32 m0, s79, 77824
    s_add_u32 s77, s15, 2097152
    s_and_b32 s77, s77, 8388607
    buffer_load_dwordx4 v6, s[24:27], s77 offen offset:0 lds
    ds_read_b64_tr_b16 a[4:5], v17 offset:28672
    ds_read_b64_tr_b16 a[6:7], v17 offset:29696
    ds_read_b64_tr_b16 a[8:9], v18 offset:28672
    v_mfma_f32_32x32x16_bf16 v[160:175], a[24:27], a[68:71], v[160:175]
    buffer_load_dwordx4 v7, s[24:27], s77 offen offset:3072 lds
    ds_read_b64_tr_b16 a[10:11], v18 offset:29696
    ds_read_b64_tr_b16 a[12:13], v19 offset:28672
    ds_read_b64_tr_b16 a[14:15], v19 offset:29696
    v_mfma_f32_32x32x16_bf16 v[176:191], a[28:31], a[68:71], v[176:191]
    s_add_u32 m0, s79, 83968
    s_nop 0
    buffer_load_dwordx4 v8, s[24:27], s77 offen offset:0 lds
    s_waitcnt lgkmcnt(6)
    v_mfma_f32_32x32x16_bf16 v[128:143], a[0:3], a[64:67], v[128:143]
    ds_read_b128 a[68:71], v13 offset:28672
    ds_read_b64_tr_b16 a[16:17], v16 offset:32768
    ds_read_b64_tr_b16 a[18:19], v16 offset:33792
    buffer_load_dwordx4 v9, s[24:27], s77 offen offset:3072 lds
    s_waitcnt lgkmcnt(7)
    v_mfma_f32_32x32x16_bf16 v[144:159], a[4:7], a[64:67], v[144:159]
    ds_read_b64_tr_b16 a[20:21], v17 offset:32768
    ds_read_b64_tr_b16 a[22:23], v17 offset:33792
    ds_read_b64_tr_b16 a[24:25], v18 offset:32768
    s_add_u32 m0, s79, 90112
    s_nop 0
    buffer_load_dwordx4 v10, s[24:27], s77 offen offset:0 lds
    s_waitcnt lgkmcnt(8)
    v_mfma_f32_32x32x16_bf16 v[160:175], a[8:11], a[64:67], v[160:175]
    ds_read_b64_tr_b16 a[26:27], v18 offset:33792
    ds_read_b64_tr_b16 a[28:29], v19 offset:32768
    ds_read_b64_tr_b16 a[30:31], v19 offset:33792
    s_cmp_lg_u32 s16, 0
    s_cbranch_scc1 L_w0_15
    buffer_load_dwordx4 v11, s[24:27], s77 offen offset:3072 lds
L_w0_15:
    s_waitcnt lgkmcnt(9)
    v_mfma_f32_32x32x16_bf16 v[176:191], a[12:15], a[64:67], v[176:191]
    s_add_u32 m0, s78, 94208
    s_add_u32 s76, s14, 512
    s_and_b32 s76, s76, 2047
    buffer_load_dwordx4 v2, s[20:23], s76 offen offset:0 lds
    s_waitcnt lgkmcnt(6)
    v_mfma_f32_32x32x16_bf16 v[128:143], a[16:19], a[68:71], v[128:143]
    ds_read_b128 a[64:67], v14 offset:28672
    ds_read_b64_tr_b16 a[0:1], v16 offset:36864
    ds_read_b64_tr_b16 a[2:3], v16 offset:37888
    buffer_load_dwordx4 v3, s[20:23], s76 offen offset:1024 lds
    s_waitcnt lgkmcnt(7)
    v_mfma_f32_32x32x16_bf16 v[144:159], a[20:23], a[68:71], v[144:159]
    ds_read_b64_tr_b16 a[4:5], v17 offset:36864
    ds_read_b64_tr_b16 a[6:7], v17 offset:37888
    ds_read_b64_tr_b16 a[8:9], v18 offset:36864
    buffer_load_dwordx4 v4, s[20:23], s76 offen offset:2048 lds
    s_waitcnt lgkmcnt(8)
    v_mfma_f32_32x32x16_bf16 v[160:175], a[24:27], a[68:71], v[160:175]
    ds_read_b64_tr_b16 a[10:11], v18 offset:37888
    ds_read_b64_tr_b16 a[12:13], v19 offset:36864
    ds_read_b64_tr_b16 a[14:15], v19 offset:37888
    buffer_load_dwordx4 v5, s[20:23], s76 offen offset:3072 lds
    s_waitcnt lgkmcnt(9)
    v_mfma_f32_32x32x16_bf16 v[176:191], a[28:31], a[68:71], v[176:191]
    s_waitcnt lgkmcnt(6)
    v_mfma_f32_32x32x16_bf16 v[128:143], a[0:3], a[64:67], v[128:143]
    ds_read_b128 a[68:71], v15 offset:28672
    ds_read_b64_tr_b16 a[16:17], v16 offset:40960
    ds_read_b64_tr_b16 a[18:19], v16 offset:41984
    s_waitcnt lgkmcnt(7)
    v_mfma_f32_32x32x16_bf16 v[144:159], a[4:7], a[64:67], v[144:159]
    ds_read_b64_tr_b16 a[20:21], v17 offset:40960
    ds_read_b64_tr_b16 a[22:23], v17 offset:41984
    ds_read_b64_tr_b16 a[24:25], v18 offset:40960
    s_waitcnt lgkmcnt(8)
    v_mfma_f32_32x32x16_bf16 v[160:175], a[8:11], a[64:67], v[160:175]
    ds_read_b64_tr_b16 a[26:27], v18 offset:41984
    ds_read_b64_tr_b16 a[28:29], v19 offset:40960
    ds_read_b64_tr_b16 a[30:31], v19 offset:41984
    s_waitcnt lgkmcnt(9)
    v_mfma_f32_32x32x16_bf16 v[176:191], a[12:15], a[64:67], v[176:191]
    s_waitcnt lgkmcnt(0)
    v_mfma_f32_32x32x16_bf16 v[128:143], a[16:19], a[68:71], v[128:143]
    s_cmp_eq_u32 s16, 0
    s_cbranch_scc1 L_wq_16
    s_waitcnt vmcnt(9)
L_wq_16:
    s_waitcnt vmcnt(10)
    s_barrier
    ds_read_b128 a[64:67], v12 offset:57344
    ds_read_b64_tr_b16 a[0:1], v20 offset:0
    ds_read_b64_tr_b16 a[2:3], v20 offset:1024
    v_mfma_f32_32x32x16_bf16 v[144:159], a[20:23], a[68:71], v[144:159]
    s_add_u32 m0, s79, 106496
    s_add_u32 s77, s15, 2621440
    s_and_b32 s77, s77, 8388607
    buffer_load_dwordx4 v6, s[24:27], s77 offen offset:0 lds
    ds_read_b64_tr_b16 a[4:5], v21 offset:0
    ds_read_b64_tr_b16 a[6:7], v21 offset:1024
    ds_read_b64_tr_b16 a[8:9], v22 offset:0
    v_mfma_f32_32x32x16_bf16 v[160:175], a[24:27], a[68:71], v[160:175]
    buffer_load_dwordx4 v7, s[24:27], s77 offen offset:3072 lds
    ds_read_b64_tr_b16 a[10:11], v22 offset:1024
    ds_read_b64_tr_b16 a[12:13], v23 offset:0
    ds_read_b64_tr_b16 a[14:15], v23 offset:1024
    v_mfma_f32_32x32x16_bf16 v[176:191], a[28:31], a[68:71], v[176:191]
    s_add_u32 m0, s79, 112640
    s_nop 0
    buffer_load_dwordx4 v8, s[24:27], s77 offen offset:0 lds
    s_waitcnt lgkmcnt(6)
    v_mfma_f32_32x32x16_bf16 v[128:143], a[0:3], a[64:67], v[128:143]
    ds_read_b128 a[68:71], v13 offset:57344
    ds_read_b64_tr_b16 a[16:17], v20 offset:4096
    ds_read_b64_tr_b16 a[18:19], v20 offset:5120
    buffer_load_dwordx4 v9, s[24:27], s77 offen offset:3072 lds
    s_waitcnt lgkmcnt(7)
    v_mfma_f32_32x32x16_bf16 v[144:159], a[4:7], a[64:67], v[144:159]
    ds_read_b64_tr_b16 a[20:21], v21 offset:4096
    ds_read_b64_tr_b16 a[22:23], v21 offset:5120
    ds_read_b64_tr_b16 a[24:25], v22 offset:4096
    s_add_u32 m0, s79, 118784
    s_nop 0
    buffer_load_dwordx4 v10, s[24:27], s77 offen offset:0 lds
    s_waitcnt lgkmcnt(8)
    v_mfma_f32_32x32x16_bf16 v[160:175], a[8:11], a[64:67], v[160:175]
    ds_read_b64_tr_b16 a[26:27], v22 offset:5120
    ds_read_b64_tr_b16 a[28:29], v23 offset:4096
    ds_read_b64_tr_b16 a[30:31], v23 offset:5120
    s_cmp_lg_u32 s16, 0
    s_cbranch_scc1 L_w0_17
    buffer_load_dwordx4 v11, s[24:27], s77 offen offset:3072 lds
L_w0_17:
    s_waitcnt lgkmcnt(9)
    v_mfma_f32_32x32x16_bf16 v[176:191], a[12:15], a[64:67], v[176:191]
    s_add_u32 m0, s78, 122880
    s_add_u32 s76, s14, 640
    s_and_b32 s76, s76, 2047
    buffer_load_dwordx4 v2, s[20:23], s76 offen offset:0 lds
    s_waitcnt lgkmcnt(6)
    v_mfma_f32_32x32x16_bf16 v[128:143], a[16:19], a[68:71], v[128:143]
    ds_read_b128 a[64:67], v14 offset:57344
    ds_read_b64_tr_b16 a[0:1], v20 offset:8192
    ds_read_b64_tr_b16 a[2:3], v20 offset:9216
    buffer_load_dwordx4 v3, s[20:23], s76 offen offset:1024 lds
    s_waitcnt lgkmcnt(7)
    v_mfma_f32_32x32x16_bf16 v[144:159], a[20:23], a[68:71], v[144:159]
    ds_read_b64_tr_b16 a[4:5], v21 offset:8192
    ds_read_b64_tr_b16 a[6:7], v21 offset:9216
    ds_read_b64_tr_b16 a[8:9], v22 offset:8192
    buffer_load_dwordx4 v4, s[20:23], s76 offen offset:2048 lds
    s_waitcnt lgkmcnt(8)
    v_mfma_f32_32x32x16_bf16 v[160:175], a[24:27], a[68:71], v[160:175]
    ds_read_b64_tr_b16 a[10:11], v22 offset:9216
    ds_read_b64_tr_b16 a[12:13], v23 offset:8192
    ds_read_b64_tr_b16 a[14:15], v23 offset:9216
    buffer_load_dwordx4 v5, s[20:23], s76 offen offset:3072 lds
    s_waitcnt lgkmcnt(9)
    v_mfma_f32_32x32x16_bf16 v[176:191], a[28:31], a[68:71], v[176:191]
    s_waitcnt lgkmcnt(6)
    v_mfma_f32_32x32x16_bf16 v[128:143], a[0:3], a[64:67], v[128:143]
    ds_read_b128 a[68:71], v15 offset:57344
    ds_read_b64_tr_b16 a[16:17], v20 offset:12288
    ds_read_b64_tr_b16 a[18:19], v20 offset:13312
    s_waitcnt lgkmcnt(7)
    v_mfma_f32_32x32x16_bf16 v[144:159], a[4:7], a[64:67], v[144:159]
    ds_read_b64_tr_b16 a[20:21], v21 offset:12288
    ds_read_b64_tr_b16 a[22:23], v21 offset:13312
    ds_read_b64_tr_b16 a[24:25], v22 offset:12288
    s_waitcnt lgkmcnt(8)
    v_mfma_f32_32x32x16_bf16 v[160:175], a[8:11], a[64:67], v[160:175]
    ds_read_b64_tr_b16 a[26:27], v22 offset:13312
    ds_read_b64_tr_b16 a[28:29], v23 offset:12288
    ds_read_b64_tr_b16 a[30:31], v23 offset:13312
    s_waitcnt lgkmcnt(9)
    v_mfma_f32_32x32x16_bf16 v[176:191], a[12:15], a[64:67], v[176:191]
    s_waitcnt lgkmcnt(0)
    v_mfma_f32_32x32x16_bf16 v[128:143], a[16:19], a[68:71], v[128:143]
    s_cmp_eq_u32 s16, 0
    s_cbranch_scc1 L_wq_18
    s_waitcnt vmcnt(9)
L_wq_18:
    s_waitcnt vmcnt(10)
    s_barrier
    ds_read_b128 a[64:67], v12 offset:0
    ds_read_b64_tr_b16 a[0:1], v16 offset:0
    ds_read_b64_tr_b16 a[2:3], v16 offset:1024
    v_mfma_f32_32x32x16_bf16 v[144:159], a[20:23], a[68:71], v[144:159]
    s_add_u32 m0, s79, 135168
    s_add_u32 s77, s15, 3145728
    s_and_b32 s77, s77, 8388607
    buffer_load_dwordx4 v6, s[24:27], s77 offen offset:0 lds
    ds_read_b64_tr_b16 a[4:5], v17 offset:0
    ds_read_b64_tr_b16 a[6:7], v17 offset:1024
    ds_read_b64_tr_b16 a[8:9], v18 offset:0
    v_mfma_f32_32x32x16_bf16 v[160:175], a[24:27], a[68:71], v[160:175]
    buffer_load_dwordx4 v7, s[24:27], s77 offen offset:3072 lds
    ds_read_b64_tr_b16 a[10:11], v18 offset:1024
    ds_read_b64_tr_b16 a[12:13], v19 offset:0
    ds_read_b64_tr_b16 a[14:15], v19 offset:1024
    v_mfma_f32_32x32x16_bf16 v[176:191], a[28:31], a[68:71], v[176:191]
    s_add_u32 m0, s79, 141312
    s_nop 0
    buffer_load_dwordx4 v8, s[24:27], s77 offen offset:0 lds
    s_waitcnt lgkmcnt(6)
    v_mfma_f32_32x32x16_bf16 v[128:143], a[0:3], a[64:67], v[128:143]
    ds_read_b128 a[68:71], v13 offset:0
    ds_read_b64_tr_b16 a[16:17], v16 offset:4096
    ds_read_b64_tr_b16 a[18:19], v16 offset:5120
    buffer_load_dwordx4 v9, s[24:27], s77 offen offset:3072 lds
    s_waitcnt lgkmcnt(7)
    v_mfma_f32_32x32x16_bf16 v[144:159], a[4:7], a[64:67], v[144:159]
    ds_read_b64_tr_b16 a[20:21], v17 offset:4096
    ds_read_b64_tr_b16 a[22:23], v17 offset:5120
    ds_read_b64_tr_b16 a[24:25], v18 offset:4096
    s_add_u32 m0, s79, 147456
    s_nop 0
    buffer_load_dwordx4 v10, s[24:27], s77 offen offset:0 lds
    s_waitcnt lgkmcnt(8)
    v_mfma_f32_32x32x16_bf16 v[160:175], a[8:11], a[64:67], v[160:175]
    ds_read_b64_tr_b16 a[26:27], v18 offset:5120
    ds_read_b64_tr_b16 a[28:29], v19 offset:4096
    ds_read_b64_tr_b16 a[30:31], v19 offset:5120
    s_cmp_lg_u32 s16, 0
    s_cbranch_scc1 L_w0_19
    buffer_load_dwordx4 v11, s[24:27], s77 offen offset:3072 lds
L_w0_19:
    s_waitcnt lgkmcnt(9)
    v_mfma_f32_32x32x16_bf16 v[176:191], a[12:15], a[64:67], v[176:191]
    s_add_u32 m0, s78, 151552
    s_add_u32 s76, s14, 768
    s_and_b32 s76, s76, 2047
    buffer_load_dwordx4 v2, s[20:23], s76 offen offset:0 lds
    s_waitcnt lgkmcnt(6)
    v_mfma_f32_32x32x16_bf16 v[128:143], a[16:19], a[68:71], v[128:143]
    ds_read_b128 a[64:67], v14 offset:0
    ds_read_b64_tr_b16 a[0:1], v16 offset:8192
    ds_read_b64_tr_b16 a[2:3], v16 offset:9216
    buffer_load_dwordx4 v3, s[20:23], s76 offen offset:1024 lds
    s_waitcnt lgkmcnt(7)
    v_mfma_f32_32x32x16_bf16 v[144:159], a[20:23], a[68:71], v[144:159]
    ds_read_b64_tr_b16 a[4:5], v17 offset:8192
    ds_read_b64_tr_b16 a[6:7], v17 offset:9216
    ds_read_b64_tr_b16 a[8:9], v18 offset:8192
    buffer_load_dwordx4 v4, s[20:23], s76 offen offset:2048 lds
    s_waitcnt lgkmcnt(8)
    v_mfma_f32_32x32x16_bf16 v[160:175], a[24:27], a[68:71], v[160:175]
    ds_read_b64_tr_b16 a[10:11], v18 offset:9216
    ds_read_b64_tr_b16 a[12:13], v19 offset:8192
    ds_read_b64_tr_b16 a[14:15], v19 offset:9216
    buffer_load_dwordx4 v5, s[20:23], s76 offen offset:3072 lds
    s_waitcnt lgkmcnt(9)
    v_mfma_f32_32x32x16_bf16 v[176:191], a[28:31], a[68:71], v[176:191]
    s_waitcnt lgkmcnt(6)
    v_mfma_f32_32x32x16_bf16 v[128:143], a[0:3], a[64:67], v[128:143]
    ds_read_b128 a[68:71], v15 offset:0
    ds_read_b64_tr_b16 a[16:17], v16 offset:12288
    ds_read_b64_tr_b16 a[18:19], v16 offset:13312
    s_waitcnt lgkmcnt(7)
    v_mfma_f32_32x32x16_bf16 v[144:159], a[4:7], a[64:67], v[144:159]
    ds_read_b64_tr_b16 a[20:21], v17 offset:12288
    ds_read_b64_tr_b16 a[22:23], v17 offset:13312
    ds_read_b64_tr_b16 a[24:25], v18 offset:12288
    s_waitcnt lgkmcnt(8)
    v_mfma_f32_32x32x16_bf16 v[160:175], a[8:11], a[64:67], v[160:175]
    ds_read_b64_tr_b16 a[26:27], v18 offset:13312
    ds_read_b64_tr_b16 a[28:29], v19 offset:12288
    ds_read_b64_tr_b16 a[30:31], v19 offset:13312
    s_waitcnt lgkmcnt(9)
    v_mfma_f32_32x32x16_bf16 v[176:191], a[12:15], a[64:67], v[176:191]
    s_waitcnt lgkmcnt(0)
    v_mfma_f32_32x32x16_bf16 v[128:143], a[16:19], a[68:71], v[128:143]
    s_cmp_eq_u32 s16, 0
    s_cbranch_scc1 L_wq_20
    s_waitcnt vmcnt(9)
L_wq_20:
    s_waitcnt vmcnt(10)
    s_barrier
    ds_read_b128 a[64:67], v12 offset:28672
    ds_read_b64_tr_b16 a[0:1], v16 offset:28672
    ds_read_b64_tr_b16 a[2:3], v16 offset:29696
    v_mfma_f32_32x32x16_bf16 v[144:159], a[20:23], a[68:71], v[144:159]
    s_add_u32 m0, s79, 77824
    s_add_u32 s77, s15, 3670016
    s_and_b32 s77, s77, 8388607
    buffer_load_dwordx4 v6, s[24:27], s77 offen offset:0 lds
    ds_read_b64_tr_b16 a[4:5], v17 offset:28672
    ds_read_b64_tr_b16 a[6:7], v17 offset:29696
    ds_read_b64_tr_b16 a[8:9], v18 offset:28672
    v_mfma_f32_32x32x16_bf16 v[160:175], a[24:27], a[68:71], v[160:175]
    buffer_load_dwordx4 v7, s[24:27], s77 offen offset:3072 lds
    ds_read_b64_tr_b16 a[10:11], v18 offset:29696
    ds_read_b64_tr_b16 a[12:13], v19 offset:28672
    ds_read_b64_tr_b16 a[14:15], v19 offset:29696
    v_mfma_f32_32x32x16_bf16 v[176:191], a[28:31], a[68:71], v[176:191]
    s_add_u32 m0, s79, 83968
    s_nop 0
    buffer_load_dwordx4 v8, s[24:27], s77 offen offset:0 lds
    s_waitcnt lgkmcnt(6)
    v_mfma_f32_32x32x16_bf16 v[128:143], a[0:3], a[64:67], v[128:143]
    ds_read_b128 a[68:71], v13 offset:28672
    ds_read_b64_tr_b16 a[16:17], v16 offset:32768
    ds_read_b64_tr_b16 a[18:19], v16 offset:33792
    buffer_load_dwordx4 v9, s[24:27], s77 offen offset:3072 lds
    s_waitcnt lgkmcnt(7)
    v_mfma_f32_32x32x16_bf16 v[144:159], a[4:7], a[64:67], v[144:159]
    ds_read_b64_tr_b16 a[20:21], v17 offset:32768
    ds_read_b64_tr_b16 a[22:23], v17 offset:33792
    ds_read_b64_tr_b16 a[24:25], v18 offset:32768
    s_add_u32 m0, s79, 90112
    s_nop 0
    buffer_load_dwordx4 v10, s[24:27], s77 offen offset:0 lds
    s_waitcnt lgkmcnt(8)
    v_mfma_f32_32x32x16_bf16 v[160:175], a[8:11], a[64:67], v[160:175]
    ds_read_b64_tr_b16 a[26:27], v18 offset:33792
    ds_read_b64_tr_b16 a[28:29], v19 offset:32768
    ds_read_b64_tr_b16 a[30:31], v19 offset:33792
    s_cmp_lg_u32 s16, 0
    s_cbranch_scc1 L_w0_21
    buffer_load_dwordx4 v11, s[24:27], s77 offen offset:3072 lds
L_w0_21:
    s_waitcnt lgkmcnt(9)
    v_mfma_f32_32x32x16_bf16 v[176:191], a[12:15], a[64:67], v[176:191]
    s_add_u32 m0, s78, 94208
    s_add_u32 s76, s14, 896
    s_and_b32 s76, s76, 2047
    buffer_load_dwordx4 v2, s[20:23], s76 offen offset:0 lds
    s_waitcnt lgkmcnt(6)
    v_mfma_f32_32x32x16_bf16 v[128:143], a[16:19], a[68:71], v[128:143]
    ds_read_b128 a[64:67], v14 offset:28672
    ds_read_b64_tr_b16 a[0:1], v16 offset:36864
    ds_read_b64_tr_b16 a[2:3], v16 offset:37888
    buffer_load_dwordx4 v3, s[20:23], s76 offen offset:1024 lds
    s_waitcnt lgkmcnt(7)
    v_mfma_f32_32x32x16_bf16 v[144:159], a[20:23], a[68:71], v[144:159]
    ds_read_b64_tr_b16 a[4:5], v17 offset:36864
    ds_read_b64_tr_b16 a[6:7], v17 offset:37888
    ds_read_b64_tr_b16 a[8:9], v18 offset:36864
    buffer_load_dwordx4 v4, s[20:23], s76 offen offset:2048 lds
    s_waitcnt lgkmcnt(8)
    v_mfma_f32_32x32x16_bf16 v[160:175], a[24:27], a[68:71], v[160:175]
    ds_read_b64_tr_b16 a[10:11], v18 offset:37888
    ds_read_b64_tr_b16 a[12:13], v19 offset:36864
    ds_read_b64_tr_b16 a[14:15], v19 offset:37888
    buffer_load_dwordx4 v5, s[20:23], s76 offen offset:3072 lds
    s_waitcnt lgkmcnt(9)
    v_mfma_f32_32x32x16_bf16 v[176:191], a[28:31], a[68:71], v[176:191]
    s_waitcnt lgkmcnt(6)
    v_mfma_f32_32x32x16_bf16 v[128:143], a[0:3], a[64:67], v[128:143]
    ds_read_b128 a[68:71], v15 offset:28672
    ds_read_b64_tr_b16 a[16:17], v16 offset:40960
    ds_read_b64_tr_b16 a[18:19], v16 offset:41984
    s_waitcnt lgkmcnt(7)
    v_mfma_f32_32x32x16_bf16 v[144:159], a[4:7], a[64:67], v[144:159]
    ds_read_b64_tr_b16 a[20:21], v17 offset:40960
    ds_read_b64_tr_b16 a[22:23], v17 offset:41984
    ds_read_b64_tr_b16 a[24:25], v18 offset:40960
    s_waitcnt lgkmcnt(8)
    v_mfma_f32_32x32x16_bf16 v[160:175], a[8:11], a[64:67], v[160:175]
    ds_read_b64_tr_b16 a[26:27], v18 offset:41984
    ds_read_b64_tr_b16 a[28:29], v19 offset:40960
    ds_read_b64_tr_b16 a[30:31], v19 offset:41984
    s_waitcnt lgkmcnt(9)
    v_mfma_f32_32x32x16_bf16 v[176:191], a[12:15], a[64:67], v[176:191]
    s_waitcnt lgkmcnt(0)
    v_mfma_f32_32x32x16_bf16 v[128:143], a[16:19], a[68:71], v[128:143]
    s_cmp_eq_u32 s16, 0
    s_cbranch_scc1 L_wq_22
    s_waitcnt vmcnt(9)
L_wq_22:
    s_waitcnt vmcnt(10)
    s_barrier
    ds_read_b128 a[64:67], v12 offset:57344
    ds_read_b64_tr_b16 a[0:1], v20 offset:0
    ds_read_b64_tr_b16 a[2:3], v20 offset:1024
    v_mfma_f32_32x32x16_bf16 v[144:159], a[20:23], a[68:71], v[144:159]
    s_add_u32 m0, s79, 106496
    s_add_u32 s77, s15, 4194304
    s_and_b32 s77, s77, 8388607
    buffer_load_dwordx4 v6, s[24:27], s77 offen offset:0 lds
    ds_read_b64_tr_b16 a[4:5], v21 offset:0
    ds_read_b64_tr_b16 a[6:7], v21 offset:1024
    ds_read_b64_tr_b16 a[8:9], v22 offset:0
    v_mfma_f32_32x32x16_bf16 v[160:175], a[24:27], a[68:71], v[160:175]
    buffer_load_dwordx4 v7, s[24:27], s77 offen offset:3072 lds
    ds_read_b64_tr_b16 a[10:11], v22 offset:1024
    ds_read_b64_tr_b16 a[12:13], v23 offset:0
    ds_read_b64_tr_b16 a[14:15], v23 offset:1024
    v_mfma_f32_32x32x16_bf16 v[176:191], a[28:31], a[68:71], v[176:191]
    s_add_u32 m0, s79, 112640
    s_nop 0
    buffer_load_dwordx4 v8, s[24:27], s77 offen offset:0 lds
    s_waitcnt lgkmcnt(6)
    v_mfma_f32_32x32x16_bf16 v[128:143], a[0:3], a[64:67], v[128:143]
    ds_read_b128 a[68:71], v13 offset:57344
    ds_read_b64_tr_b16 a[16:17], v20 offset:4096
    ds_read_b64_tr_b16 a[18:19], v20 offset:5120
    buffer_load_dwordx4 v9, s[24:27], s77 offen offset:3072 lds
    s_waitcnt lgkmcnt(7)
    v_mfma_f32_32x32x16_bf16 v[144:159], a[4:7], a[64:67], v[144:159]
    ds_read_b64_tr_b16 a[20:21], v21 offset:4096
    ds_read_b64_tr_b16 a[22:23], v21 offset:5120
    ds_read_b64_tr_b16 a[24:25], v22 offset:4096
    s_add_u32 m0, s79, 118784
    s_nop 0
    buffer_load_dwordx4 v10, s[24:27], s77 offen offset:0 lds
    s_waitcnt lgkmcnt(8)
    v_mfma_f32_32x32x16_bf16 v[160:175], a[8:11], a[64:67], v[160:175]
    ds_read_b64_tr_b16 a[26:27], v22 offset:5120
    ds_read_b64_tr_b16 a[28:29], v23 offset:4096
    ds_read_b64_tr_b16 a[30:31], v23 offset:5120
    s_cmp_lg_u32 s16, 0
    s_cbranch_scc1 L_w0_23
    buffer_load_dwordx4 v11, s[24:27], s77 offen offset:3072 lds
L_w0_23:
    s_waitcnt lgkmcnt(9)
    v_mfma_f32_32x32x16_bf16 v[176:191], a[12:15], a[64:67], v[176:191]
    s_add_u32 m0, s78, 122880
    s_add_u32 s76, s14, 1024
    s_and_b32 s76, s76, 2047
    buffer_load_dwordx4 v2, s[20:23], s76 offen offset:0 lds
    s_waitcnt lgkmcnt(6)
    v_mfma_f32_32x32x16_bf16 v[128:143], a[16:19], a[68:71], v[128:143]
    ds_read_b128 a[64:67], v14 offset:57344
    ds_read_b64_tr_b16 a[0:1], v20 offset:8192
    ds_read_b64_tr_b16 a[2:3], v20 offset:9216
    buffer_load_dwordx4 v3, s[20:23], s76 offen offset:1024 lds
    s_waitcnt lgkmcnt(7)
    v_mfma_f32_32x32x16_bf16 v[144:159], a[20:23], a[68:71], v[144:159]
    ds_read_b64_tr_b16 a[4:5], v21 offset:8192
    ds_read_b64_tr_b16 a[6:7], v21 offset:9216
    ds_read_b64_tr_b16 a[8:9], v22 offset:8192
    buffer_load_dwordx4 v4, s[20:23], s76 offen offset:2048 lds
    s_waitcnt lgkmcnt(8)
    v_mfma_f32_32x32x16_bf16 v[160:175], a[24:27], a[68:71], v[160:175]
    ds_read_b64_tr_b16 a[10:11], v22 offset:9216
    ds_read_b64_tr_b16 a[12:13], v23 offset:8192
    ds_read_b64_tr_b16 a[14:15], v23 offset:9216
    buffer_load_dwordx4 v5, s[20:23], s76 offen offset:3072 lds
    s_waitcnt lgkmcnt(9)
    v_mfma_f32_32x32x16_bf16 v[176:191], a[28:31], a[68:71], v[176:191]
    s_waitcnt lgkmcnt(6)
    v_mfma_f32_32x32x16_bf16 v[128:143], a[0:3], a[64:67], v[128:143]
    ds_read_b128 a[68:71], v15 offset:57344
    ds_read_b64_tr_b16 a[16:17], v20 offset:12288
    ds_read_b64_tr_b16 a[18:19], v20 offset:13312
    s_waitcnt lgkmcnt(7)
    v_mfma_f32_32x32x16_bf16 v[144:159], a[4:7], a[64:67], v[144:159]
    ds_read_b64_tr_b16 a[20:21], v21 offset:12288
    ds_read_b64_tr_b16 a[22:23], v21 offset:13312
    ds_read_b64_tr_b16 a[24:25], v22 offset:12288
    s_waitcnt lgkmcnt(8)
    v_mfma_f32_32x32x16_bf16 v[160:175], a[8:11], a[64:67], v[160:175]
    ds_read_b64_tr_b16 a[26:27], v22 offset:13312
    ds_read_b64_tr_b16 a[28:29], v23 offset:12288
    ds_read_b64_tr_b16 a[30:31], v23 offset:13312
    s_waitcnt lgkmcnt(9)
    v_mfma_f32_32x32x16_bf16 v[176:191], a[12:15], a[64:67], v[176:191]
    s_waitcnt lgkmcnt(0)
    v_mfma_f32_32x32x16_bf16 v[128:143], a[16:19], a[68:71], v[128:143]
    s_cmp_eq_u32 s16, 0
    s_cbranch_scc1 L_wq_24
    s_waitcnt vmcnt(9)
L_wq_24:
    s_waitcnt vmcnt(10)
    s_barrier
    ds_read_b128 a[64:67], v12 offset:0
    ds_read_b64_tr_b16 a[0:1], v16 offset:0
    ds_read_b64_tr_b16 a[2:3], v16 offset:1024
    v_mfma_f32_32x32x16_bf16 v[144:159], a[20:23], a[68:71], v[144:159]
    s_add_u32 m0, s79, 135168
    s_add_u32 s77, s15, 4718592
    s_and_b32 s77, s77, 8388607
    buffer_load_dwordx4 v6, s[24:27], s77 offen offset:0 lds
    ds_read_b64_tr_b16 a[4:5], v17 offset:0
    ds_read_b64_tr_b16 a[6:7], v17 offset:1024
    ds_read_b64_tr_b16 a[8:9], v18 offset:0
    v_mfma_f32_32x32x16_bf16 v[160:175], a[24:27], a[68:71], v[160:175]
    buffer_load_dwordx4 v7, s[24:27], s77 offen offset:3072 lds
    ds_read_b64_tr_b16 a[10:11], v18 offset:1024
    ds_read_b64_tr_b16 a[12:13], v19 offset:0
    ds_read_b64_tr_b16 a[14:15], v19 offset:1024
    v_mfma_f32_32x32x16_bf16 v[176:191], a[28:31], a[68:71], v[176:191]
    s_add_u32 m0, s79, 141312
    s_nop 0
    buffer_load_dwordx4 v8, s[24:27], s77 offen offset:0 lds
    s_waitcnt lgkmcnt(6)
    v_mfma_f32_32x32x16_bf16 v[128:143], a[0:3], a[64:67], v[128:143]
    ds_read_b128 a[68:71], v13 offset:0
    ds_read_b64_tr_b16 a[16:17], v16 offset:4096
    ds_read_b64_tr_b16 a[18:19], v16 offset:5120
    buffer_load_dwordx4 v9, s[24:27], s77 offen offset:3072 lds
    s_waitcnt lgkmcnt(7)
    v_mfma_f32_32x32x16_bf16 v[144:159], a[4:7], a[64:67], v[144:159]
    ds_read_b64_tr_b16 a[20:21], v17 offset:4096
    ds_read_b64_tr_b16 a[22:23], v17 offset:5120
    ds_read_b64_tr_b16 a[24:25], v18 offset:4096
    s_add_u32 m0, s79, 147456
    s_nop 0
    buffer_load_dwordx4 v10, s[24:27], s77 offen offset:0 lds
    s_waitcnt lgkmcnt(8)
    v_mfma_f32_32x32x16_bf16 v[160:175], a[8:11], a[64:67], v[160:175]
    ds_read_b64_tr_b16 a[26:27], v18 offset:5120
    ds_read_b64_tr_b16 a[28:29], v19 offset:4096
    ds_read_b64_tr_b16 a[30:31], v19 offset:5120
    s_cmp_lg_u32 s16, 0
    s_cbranch_scc1 L_w0_25
    buffer_load_dwordx4 v11, s[24:27], s77 offen offset:3072 lds
L_w0_25:
    s_waitcnt lgkmcnt(9)
    v_mfma_f32_32x32x16_bf16 v[176:191], a[12:15], a[64:67], v[176:191]
    s_add_u32 m0, s78, 151552
    s_add_u32 s76, s14, 1152
    s_and_b32 s76, s76, 2047
    buffer_load_dwordx4 v2, s[20:23], s76 offen offset:0 lds
    s_waitcnt lgkmcnt(6)
    v_mfma_f32_32x32x16_bf16 v[128:143], a[16:19], a[68:71], v[128:143]
    ds_read_b128 a[64:67], v14 offset:0
    ds_read_b64_tr_b16 a[0:1], v16 offset:8192
    ds_read_b64_tr_b16 a[2:3], v16 offset:9216
    buffer_load_dwordx4 v3, s[20:23], s76 offen offset:1024 lds
    s_waitcnt lgkmcnt(7)
    v_mfma_f32_32x32x16_bf16 v[144:159], a[20:23], a[68:71], v[144:159]
    ds_read_b64_tr_b16 a[4:5], v17 offset:8192
    ds_read_b64_tr_b16 a[6:7], v17 offset:9216
    ds_read_b64_tr_b16 a[8:9], v18 offset:8192
    buffer_load_dwordx4 v4, s[20:23], s76 offen offset:2048 lds
    s_waitcnt lgkmcnt(8)
    v_mfma_f32_32x32x16_bf16 v[160:175], a[24:27], a[68:71], v[160:175]
    ds_read_b64_tr_b16 a[10:11], v18 offset:9216
    ds_read_b64_tr_b16 a[12:13], v19 offset:8192
    ds_read_b64_tr_b16 a[14:15], v19 offset:9216
    buffer_load_dwordx4 v5, s[20:23], s76 offen offset:3072 lds
    s_waitcnt lgkmcnt(9)
    v_mfma_f32_32x32x16_bf16 v[176:191], a[28:31], a[68:71], v[176:191]
    s_waitcnt lgkmcnt(6)
    v_mfma_f32_32x32x16_bf16 v[128:143], a[0:3], a[64:67], v[128:143]
    ds_read_b128 a[68:71], v15 offset:0
    ds_read_b64_tr_b16 a[16:17], v16 offset:12288
    ds_read_b64_tr_b16 a[18:19], v16 offset:13312
    s_waitcnt lgkmcnt(7)
    v_mfma_f32_32x32x16_bf16 v[144:159], a[4:7], a[64:67], v[144:159]
    ds_read_b64_tr_b16 a[20:21], v17 offset:12288
    ds_read_b64_tr_b16 a[22:23], v17 offset:13312
    ds_read_b64_tr_b16 a[24:25], v18 offset:12288
    s_waitcnt lgkmcnt(8)
    v_mfma_f32_32x32x16_bf16 v[160:175], a[8:11], a[64:67], v[160:175]
    ds_read_b64_tr_b16 a[26:27], v18 offset:13312
    ds_read_b64_tr_b16 a[28:29], v19 offset:12288
    ds_read_b64_tr_b16 a[30:31], v19 offset:13312
    s_waitcnt lgkmcnt(9)
    v_mfma_f32_32x32x16_bf16 v[176:191], a[12:15], a[64:67], v[176:191]
    s_waitcnt lgkmcnt(0)
    v_mfma_f32_32x32x16_bf16 v[128:143], a[16:19], a[68:71], v[128:143]
    s_cmp_eq_u32 s16, 0
    s_cbranch_scc1 L_wq_26
    s_waitcnt vmcnt(9)
L_wq_26:
    s_waitcnt vmcnt(10)
    s_barrier
    ds_read_b128 a[64:67], v12 offset:28672
    ds_read_b64_tr_b16 a[0:1], v16 offset:28672
    ds_read_b64_tr_b16 a[2:3], v16 offset:29696
    v_mfma_f32_32x32x16_bf16 v[144:159], a[20:23], a[68:71], v[144:159]
    s_add_u32 m0, s79, 77824
    s_add_u32 s77, s15, 5242880
    s_and_b32 s77, s77, 8388607
    buffer_load_dwordx4 v6, s[24:27], s77 offen offset:0 lds
    ds_read_b64_tr_b16 a[4:5], v17 offset:28672
    ds_read_b64_tr_b16 a[6:7], v17 offset:29696
    ds_read_b64_tr_b16 a[8:9], v18 offset:28672
    v_mfma_f32_32x32x16_bf16 v[160:175], a[24:27], a[68:71], v[160:175]
    buffer_load_dwordx4 v7, s[24:27], s77 offen offset:3072 lds
    ds_read_b64_tr_b16 a[10:11], v18 offset:29696
    ds_read_b64_tr_b16 a[12:13], v19 offset:28672
    ds_read_b64_tr_b16 a[14:15], v19 offset:29696
    v_mfma_f32_32x32x16_bf16 v[176:191], a[28:31], a[68:71], v[176:191]
    s_add_u32 m0, s79, 83968
    s_nop 0
    buffer_load_dwordx4 v8, s[24:27], s77 offen offset:0 lds
    s_waitcnt lgkmcnt(6)
    v_mfma_f32_32x32x16_bf16 v[128:143], a[0:3], a[64:67], v[128:143]
    ds_read_b128 a[68:71], v13 offset:28672
    ds_read_b64_tr_b16 a[16:17], v16 offset:32768
    ds_read_b64_tr_b16 a[18:19], v16 offset:33792
    buffer_load_dwordx4 v9, s[24:27], s77 offen offset:3072 lds
    s_waitcnt lgkmcnt(7)
    v_mfma_f32_32x32x16_bf16 v[144:159], a[4:7], a[64:67], v[144:159]
    ds_read_b64_tr_b16 a[20:21], v17 offset:32768
    ds_read_b64_tr_b16 a[22:23], v17 offset:33792
    ds_read_b64_tr_b16 a[24:25], v18 offset:32768
    s_add_u32 m0, s79, 90112
    s_nop 0
    buffer_load_dwordx4 v10, s[24:27], s77 offen offset:0 lds
    s_waitcnt lgkmcnt(8)
    v_mfma_f32_32x32x16_bf16 v[160:175], a[8:11], a[64:67], v[160:175]
    ds_read_b64_tr_b16 a[26:27], v18 offset:33792
    ds_read_b64_tr_b16 a[28:29], v19 offset:32768
    ds_read_b64_tr_b16 a[30:31], v19 offset:33792
    s_cmp_lg_u32 s16, 0
    s_cbranch_scc1 L_w0_27
    buffer_load_dwordx4 v11, s[24:27], s77 offen offset:3072 lds
L_w0_27:
    s_waitcnt lgkmcnt(9)
    v_mfma_f32_32x32x16_bf16 v[176:191], a[12:15], a[64:67], v[176:191]
    s_add_u32 m0, s78, 94208
    s_add_u32 s76, s14, 1280
    s_and_b32 s76, s76, 2047
    buffer_load_dwordx4 v2, s[20:23], s76 offen offset:0 lds
    s_waitcnt lgkmcnt(6)
    v_mfma_f32_32x32x16_bf16 v[128:143], a[16:19], a[68:71], v[128:143]
    ds_read_b128 a[64:67], v14 offset:28672
    ds_read_b64_tr_b16 a[0:1], v16 offset:36864
    ds_read_b64_tr_b16 a[2:3], v16 offset:37888
    buffer_load_dwordx4 v3, s[20:23], s76 offen offset:1024 lds
    s_waitcnt lgkmcnt(7)
    v_mfma_f32_32x32x16_bf16 v[144:159], a[20:23], a[68:71], v[144:159]
    ds_read_b64_tr_b16 a[4:5], v17 offset:36864
    ds_read_b64_tr_b16 a[6:7], v17 offset:37888
    ds_read_b64_tr_b16 a[8:9], v18 offset:36864
    buffer_load_dwordx4 v4, s[20:23], s76 offen offset:2048 lds
    s_waitcnt lgkmcnt(8)
    v_mfma_f32_32x32x16_bf16 v[160:175], a[24:27], a[68:71], v[160:175]
    ds_read_b64_tr_b16 a[10:11], v18 offset:37888
    ds_read_b64_tr_b16 a[12:13], v19 offset:36864
    ds_read_b64_tr_b16 a[14:15], v19 offset:37888
    buffer_load_dwordx4 v5, s[20:23], s76 offen offset:3072 lds
    s_waitcnt lgkmcnt(9)
    v_mfma_f32_32x32x16_bf16 v[176:191], a[28:31], a[68:71], v[176:191]
    s_waitcnt lgkmcnt(6)
    v_mfma_f32_32x32x16_bf16 v[128:143], a[0:3], a[64:67], v[128:143]
    ds_read_b128 a[68:71], v15 offset:28672
    ds_read_b64_tr_b16 a[16:17], v16 offset:40960
    ds_read_b64_tr_b16 a[18:19], v16 offset:41984
    s_waitcnt lgkmcnt(7)
    v_mfma_f32_32x32x16_bf16 v[144:159], a[4:7], a[64:67], v[144:159]
    ds_read_b64_tr_b16 a[20:21], v17 offset:40960
    ds_read_b64_tr_b16 a[22:23], v17 offset:41984
    ds_read_b64_tr_b16 a[24:25], v18 offset:40960
    s_waitcnt lgkmcnt(8)
    v_mfma_f32_32x32x16_bf16 v[160:175], a[8:11], a[64:67], v[160:175]
    ds_read_b64_tr_b16 a[26:27], v18 offset:41984
    ds_read_b64_tr_b16 a[28:29], v19 offset:40960
    ds_read_b64_tr_b16 a[30:31], v19 offset:41984
    s_waitcnt lgkmcnt(9)
    v_mfma_f32_32x32x16_bf16 v[176:191], a[12:15], a[64:67], v[176:191]
    s_waitcnt lgkmcnt(0)
    v_mfma_f32_32x32x16_bf16 v[128:143], a[16:19], a[68:71], v[128:143]
    s_cmp_eq_u32 s16, 0
    s_cbranch_scc1 L_wq_28
    s_waitcnt vmcnt(9)
L_wq_28:
    s_waitcnt vmcnt(10)
    s_barrier
    ds_read_b128 a[64:67], v12 offset:57344
    ds_read_b64_tr_b16 a[0:1], v20 offset:0
    ds_read_b64_tr_b16 a[2:3], v20 offset:1024
    v_mfma_f32_32x32x16_bf16 v[144:159], a[20:23], a[68:71], v[144:159]
    s_add_u32 m0, s79, 106496
    s_add_u32 s77, s15, 5767168
    s_and_b32 s77, s77, 8388607
    buffer_load_dwordx4 v6, s[24:27], s77 offen offset:0 lds
    ds_read_b64_tr_b16 a[4:5], v21 offset:0
    ds_read_b64_tr_b16 a[6:7], v21 offset:1024
    ds_read_b64_tr_b16 a[8:9], v22 offset:0
    v_mfma_f32_32x32x16_bf16 v[160:175], a[24:27], a[68:71], v[160:175]
    buffer_load_dwordx4 v7, s[24:27], s77 offen offset:3072 lds
    ds_read_b64_tr_b16 a[10:11], v22 offset:1024
    ds_read_b64_tr_b16 a[12:13], v23 offset:0
    ds_read_b64_tr_b16 a[14:15], v23 offset:1024
    v_mfma_f32_32x32x16_bf16 v[176:191], a[28:31], a[68:71], v[176:191]
    s_add_u32 m0, s79, 112640
    s_nop 0
    buffer_load_dwordx4 v8, s[24:27], s77 offen offset:0 lds
    s_waitcnt lgkmcnt(6)
    v_mfma_f32_32x32x16_bf16 v[128:143], a[0:3], a[64:67], v[128:143]
    ds_read_b128 a[68:71], v13 offset:57344
    ds_read_b64_tr_b16 a[16:17], v20 offset:4096
    ds_read_b64_tr_b16 a[18:19], v20 offset:5120
    buffer_load_dwordx4 v9, s[24:27], s77 offen offset:3072 lds
    s_waitcnt lgkmcnt(7)
    v_mfma_f32_32x32x16_bf16 v[144:159], a[4:7], a[64:67], v[144:159]
    ds_read_b64_tr_b16 a[20:21], v21 offset:4096
    ds_read_b64_tr_b16 a[22:23], v21 offset:5120
    ds_read_b64_tr_b16 a[24:25], v22 offset:4096
    s_add_u32 m0, s79, 118784
    s_nop 0
    buffer_load_dwordx4 v10, s[24:27], s77 offen offset:0 lds
    s_waitcnt lgkmcnt(8)
    v_mfma_f32_32x32x16_bf16 v[160:175], a[8:11], a[64:67], v[160:175]
    ds_read_b64_tr_b16 a[26:27], v22 offset:5120
    ds_read_b64_tr_b16 a[28:29], v23 offset:4096
    ds_read_b64_tr_b16 a[30:31], v23 offset:5120
    s_cmp_lg_u32 s16, 0
    s_cbranch_scc1 L_w0_29
    buffer_load_dwordx4 v11, s[24:27], s77 offen offset:3072 lds
L_w0_29:
    s_waitcnt lgkmcnt(9)
    v_mfma_f32_32x32x16_bf16 v[176:191], a[12:15], a[64:67], v[176:191]
    s_add_u32 m0, s78, 122880
    s_add_u32 s76, s14, 1408
    s_and_b32 s76, s76, 2047
    buffer_load_dwordx4 v2, s[20:23], s76 offen offset:0 lds
    s_waitcnt lgkmcnt(6)
    v_mfma_f32_32x32x16_bf16 v[128:143], a[16:19], a[68:71], v[128:143]
    ds_read_b128 a[64:67], v14 offset:57344
    ds_read_b64_tr_b16 a[0:1], v20 offset:8192
    ds_read_b64_tr_b16 a[2:3], v20 offset:9216
    buffer_load_dwordx4 v3, s[20:23], s76 offen offset:1024 lds
    s_waitcnt lgkmcnt(7)
    v_mfma_f32_32x32x16_bf16 v[144:159], a[20:23], a[68:71], v[144:159]
    ds_read_b64_tr_b16 a[4:5], v21 offset:8192
    ds_read_b64_tr_b16 a[6:7], v21 offset:9216
    ds_read_b64_tr_b16 a[8:9], v22 offset:8192
    buffer_load_dwordx4 v4, s[20:23], s76 offen offset:2048 lds
    s_waitcnt lgkmcnt(8)
    v_mfma_f32_32x32x16_bf16 v[160:175], a[24:27], a[68:71], v[160:175]
    ds_read_b64_tr_b16 a[10:11], v22 offset:9216
    ds_read_b64_tr_b16 a[12:13], v23 offset:8192
    ds_read_b64_tr_b16 a[14:15], v23 offset:9216
    buffer_load_dwordx4 v5, s[20:23], s76 offen offset:3072 lds
    s_waitcnt lgkmcnt(9)
    v_mfma_f32_32x32x16_bf16 v[176:191], a[28:31], a[68:71], v[176:191]
    s_waitcnt lgkmcnt(6)
    v_mfma_f32_32x32x16_bf16 v[128:143], a[0:3], a[64:67], v[128:143]
    ds_read_b128 a[68:71], v15 offset:57344
    ds_read_b64_tr_b16 a[16:17], v20 offset:12288
    ds_read_b64_tr_b16 a[18:19], v20 offset:13312
    s_waitcnt lgkmcnt(7)
    v_mfma_f32_32x32x16_bf16 v[144:159], a[4:7], a[64:67], v[144:159]
    ds_read_b64_tr_b16 a[20:21], v21 offset:12288
    ds_read_b64_tr_b16 a[22:23], v21 offset:13312
    ds_read_b64_tr_b16 a[24:25], v22 offset:12288
    s_waitcnt lgkmcnt(8)
    v_mfma_f32_32x32x16_bf16 v[160:175], a[8:11], a[64:67], v[160:175]
    ds_read_b64_tr_b16 a[26:27], v22 offset:13312
    ds_read_b64_tr_b16 a[28:29], v23 offset:12288
    ds_read_b64_tr_b16 a[30:31], v23 offset:13312
    s_waitcnt lgkmcnt(9)
    v_mfma_f32_32x32x16_bf16 v[176:191], a[12:15], a[64:67], v[176:191]
    s_waitcnt lgkmcnt(0)
    v_mfma_f32_32x32x16_bf16 v[128:143], a[16:19], a[68:71], v[128:143]
    s_cmp_eq_u32 s16, 0
    s_cbranch_scc1 L_wq_30
    s_waitcnt vmcnt(9)
L_wq_30:
    s_waitcnt vmcnt(10)
    s_barrier
    ds_read_b128 a[64:67], v12 offset:0
    ds_read_b64_tr_b16 a[0:1], v16 offset:0
    ds_read_b64_tr_b16 a[2:3], v16 offset:1024
    v_mfma_f32_32x32x16_bf16 v[144:159], a[20:23], a[68:71], v[144:159]
    s_add_u32 m0, s79, 135168
    s_add_u32 s77, s15, 6291456
    s_and_b32 s77, s77, 8388607
    buffer_load_dwordx4 v6, s[24:27], s77 offen offset:0 lds
    ds_read_b64_tr_b16 a[4:5], v17 offset:0
    ds_read_b64_tr_b16 a[6:7], v17 offset:1024
    ds_read_b64_tr_b16 a[8:9], v18 offset:0
    v_mfma_f32_32x32x16_bf16 v[160:175], a[24:27], a[68:71], v[160:175]
    buffer_load_dwordx4 v7, s[24:27], s77 offen offset:3072 lds
    ds_read_b64_tr_b16 a[10:11], v18 offset:1024
    ds_read_b64_tr_b16 a[12:13], v19 offset:0
    ds_read_b64_tr_b16 a[14:15], v19 offset:1024
    v_mfma_f32_32x32x16_bf16 v[176:191], a[28:31], a[68:71], v[176:191]
    s_add_u32 m0, s79, 141312
    s_nop 0
    buffer_load_dwordx4 v8, s[24:27], s77 offen offset:0 lds
    s_waitcnt lgkmcnt(6)
    v_mfma_f32_32x32x16_bf16 v[128:143], a[0:3], a[64:67], v[128:143]
    ds_read_b128 a[68:71], v13 offset:0
    ds_read_b64_tr_b16 a[16:17], v16 offset:4096
    ds_read_b64_tr_b16 a[18:19], v16 offset:5120
    buffer_load_dwordx4 v9, s[24:27], s77 offen offset:3072 lds
    s_waitcnt lgkmcnt(7)
    v_mfma_f32_32x32x16_bf16 v[144:159], a[4:7], a[64:67], v[144:159]
    ds_read_b64_tr_b16 a[20:21], v17 offset:4096
    ds_read_b64_tr_b16 a[22:23], v17 offset:5120
    ds_read_b64_tr_b16 a[24:25], v18 offset:4096
    s_add_u32 m0, s79, 147456
    s_nop 0
    buffer_load_dwordx4 v10, s[24:27], s77 offen offset:0 lds
    s_waitcnt lgkmcnt(8)
    v_mfma_f32_32x32x16_bf16 v[160:175], a[8:11], a[64:67], v[160:175]
    ds_read_b64_tr_b16 a[26:27], v18 offset:5120
    ds_read_b64_tr_b16 a[28:29], v19 offset:4096
    ds_read_b64_tr_b16 a[30:31], v19 offset:5120
    s_cmp_lg_u32 s16, 0
    s_cbranch_scc1 L_w0_31
    buffer_load_dwordx4 v11, s[24:27], s77 offen offset:3072 lds
L_w0_31:
    s_waitcnt lgkmcnt(9)
    v_mfma_f32_32x32x16_bf16 v[176:191], a[12:15], a[64:67], v[176:191]
    s_add_u32 m0, s78, 151552
    s_add_u32 s76, s14, 1536
    s_and_b32 s76, s76, 2047
    buffer_load_dwordx4 v2, s[20:23], s76 offen offset:0 lds
    s_waitcnt lgkmcnt(6)
    v_mfma_f32_32x32x16_bf16 v[128:143], a[16:19], a[68:71], v[128:143]
    ds_read_b128 a[64:67], v14 offset:0
    ds_read_b64_tr_b16 a[0:1], v16 offset:8192
    ds_read_b64_tr_b16 a[2:3], v16 offset:9216
    buffer_load_dwordx4 v3, s[20:23], s76 offen offset:1024 lds
    s_waitcnt lgkmcnt(7)
    v_mfma_f32_32x32x16_bf16 v[144:159], a[20:23], a[68:71], v[144:159]
    ds_read_b64_tr_b16 a[4:5], v17 offset:8192
    ds_read_b64_tr_b16 a[6:7], v17 offset:9216
    ds_read_b64_tr_b16 a[8:9], v18 offset:8192
    buffer_load_dwordx4 v4, s[20:23], s76 offen offset:2048 lds
    s_waitcnt lgkmcnt(8)
    v_mfma_f32_32x32x16_bf16 v[160:175], a[24:27], a[68:71], v[160:175]
    ds_read_b64_tr_b16 a[10:11], v18 offset:9216
    ds_read_b64_tr_b16 a[12:13], v19 offset:8192
    ds_read_b64_tr_b16 a[14:15], v19 offset:9216
    buffer_load_dwordx4 v5, s[20:23], s76 offen offset:3072 lds
    s_waitcnt lgkmcnt(9)
    v_mfma_f32_32x32x16_bf16 v[176:191], a[28:31], a[68:71], v[176:191]
    s_waitcnt lgkmcnt(6)
    v_mfma_f32_32x32x16_bf16 v[128:143], a[0:3], a[64:67], v[128:143]
    ds_read_b128 a[68:71], v15 offset:0
    ds_read_b64_tr_b16 a[16:17], v16 offset:12288
    ds_read_b64_tr_b16 a[18:19], v16 offset:13312
    s_waitcnt lgkmcnt(7)
    v_mfma_f32_32x32x16_bf16 v[144:159], a[4:7], a[64:67], v[144:159]
    ds_read_b64_tr_b16 a[20:21], v17 offset:12288
    ds_read_b64_tr_b16 a[22:23], v17 offset:13312
    ds_read_b64_tr_b16 a[24:25], v18 offset:12288
    s_waitcnt lgkmcnt(8)
    v_mfma_f32_32x32x16_bf16 v[160:175], a[8:11], a[64:67], v[160:175]
    ds_read_b64_tr_b16 a[26:27], v18 offset:13312
    ds_read_b64_tr_b16 a[28:29], v19 offset:12288
    ds_read_b64_tr_b16 a[30:31], v19 offset:13312
    s_waitcnt lgkmcnt(9)
    v_mfma_f32_32x32x16_bf16 v[176:191], a[12:15], a[64:67], v[176:191]
    s_waitcnt lgkmcnt(0)
    v_mfma_f32_32x32x16_bf16 v[128:143], a[16:19], a[68:71], v[128:143]
    s_cmp_eq_u32 s16, 0
    s_cbranch_scc1 L_wq_32
    s_waitcnt vmcnt(9)
L_wq_32:
    s_waitcnt vmcnt(10)
    s_barrier
    ds_read_b128 a[64:67], v12 offset:28672
    ds_read_b64_tr_b16 a[0:1], v16 offset:28672
    ds_read_b64_tr_b16 a[2:3], v16 offset:29696
    v_mfma_f32_32x32x16_bf16 v[144:159], a[20:23], a[68:71], v[144:159]
    s_add_u32 m0, s79, 77824
    s_add_u32 s77, s15, 6815744
    s_and_b32 s77, s77, 8388607
    buffer_load_dwordx4 v6, s[24:27], s77 offen offset:0 lds
    ds_read_b64_tr_b16 a[4:5], v17 offset:28672
    ds_read_b64_tr_b16 a[6:7], v17 offset:29696
    ds_read_b64_tr_b16 a[8:9], v18 offset:28672
    v_mfma_f32_32x32x16_bf16 v[160:175], a[24:27], a[68:71], v[160:175]
    buffer_load_dwordx4 v7, s[24:27], s77 offen offset:3072 lds
    ds_read_b64_tr_b16 a[10:11], v18 offset:29696
    ds_read_b64_tr_b16 a[12:13], v19 offset:28672
    ds_read_b64_tr_b16 a[14:15], v19 offset:29696
    v_mfma_f32_32x32x16_bf16 v[176:191], a[28:31], a[68:71], v[176:191]
    s_add_u32 m0, s79, 83968
    s_nop 0
    buffer_load_dwordx4 v8, s[24:27], s77 offen offset:0 lds
    s_waitcnt lgkmcnt(6)
    v_mfma_f32_32x32x16_bf16 v[128:143], a[0:3], a[64:67], v[128:143]
    ds_read_b128 a[68:71], v13 offset:28672
    ds_read_b64_tr_b16 a[16:17], v16 offset:32768
    ds_read_b64_tr_b16 a[18:19], v16 offset:33792
    buffer_load_dwordx4 v9, s[24:27], s77 offen offset:3072 lds
    s_waitcnt lgkmcnt(7)
    v_mfma_f32_32x32x16_bf16 v[144:159], a[4:7], a[64:67], v[144:159]
    ds_read_b64_tr_b16 a[20:21], v17 offset:32768
    ds_read_b64_tr_b16 a[22:23], v17 offset:33792
    ds_read_b64_tr_b16 a[24:25], v18 offset:32768
    s_add_u32 m0, s79, 90112
    s_nop 0
    buffer_load_dwordx4 v10, s[24:27], s77 offen offset:0 lds
    s_waitcnt lgkmcnt(8)
    v_mfma_f32_32x32x16_bf16 v[160:175], a[8:11], a[64:67], v[160:175]
    ds_read_b64_tr_b16 a[26:27], v18 offset:33792
    ds_read_b64_tr_b16 a[28:29], v19 offset:32768
    ds_read_b64_tr_b16 a[30:31], v19 offset:33792
    s_cmp_lg_u32 s16, 0
    s_cbranch_scc1 L_w0_33
    buffer_load_dwordx4 v11, s[24:27], s77 offen offset:3072 lds
L_w0_33:
    s_waitcnt lgkmcnt(9)
    v_mfma_f32_32x32x16_bf16 v[176:191], a[12:15], a[64:67], v[176:191]
    s_add_u32 m0, s78, 94208
    s_add_u32 s76, s14, 1664
    s_and_b32 s76, s76, 2047
    buffer_load_dwordx4 v2, s[20:23], s76 offen offset:0 lds
    s_waitcnt lgkmcnt(6)
    v_mfma_f32_32x32x16_bf16 v[128:143], a[16:19], a[68:71], v[128:143]
    ds_read_b128 a[64:67], v14 offset:28672
    ds_read_b64_tr_b16 a[0:1], v16 offset:36864
    ds_read_b64_tr_b16 a[2:3], v16 offset:37888
    buffer_load_dwordx4 v3, s[20:23], s76 offen offset:1024 lds
    s_waitcnt lgkmcnt(7)
    v_mfma_f32_32x32x16_bf16 v[144:159], a[20:23], a[68:71], v[144:159]
    ds_read_b64_tr_b16 a[4:5], v17 offset:36864
    ds_read_b64_tr_b16 a[6:7], v17 offset:37888
    ds_read_b64_tr_b16 a[8:9], v18 offset:36864
    buffer_load_dwordx4 v4, s[20:23], s76 offen offset:2048 lds
    s_waitcnt lgkmcnt(8)
    v_mfma_f32_32x32x16_bf16 v[160:175], a[24:27], a[68:71], v[160:175]
    ds_read_b64_tr_b16 a[10:11], v18 offset:37888
    ds_read_b64_tr_b16 a[12:13], v19 offset:36864
    ds_read_b64_tr_b16 a[14:15], v19 offset:37888
    buffer_load_dwordx4 v5, s[20:23], s76 offen offset:3072 lds
    s_waitcnt lgkmcnt(9)
    v_mfma_f32_32x32x16_bf16 v[176:191], a[28:31], a[68:71], v[176:191]
    s_waitcnt lgkmcnt(6)
    v_mfma_f32_32x32x16_bf16 v[128:143], a[0:3], a[64:67], v[128:143]
    ds_read_b128 a[68:71], v15 offset:28672
    ds_read_b64_tr_b16 a[16:17], v16 offset:40960
    ds_read_b64_tr_b16 a[18:19], v16 offset:41984
    s_waitcnt lgkmcnt(7)
    v_mfma_f32_32x32x16_bf16 v[144:159], a[4:7], a[64:67], v[144:159]
    ds_read_b64_tr_b16 a[20:21], v17 offset:40960
    ds_read_b64_tr_b16 a[22:23], v17 offset:41984
    ds_read_b64_tr_b16 a[24:25], v18 offset:40960
    s_waitcnt lgkmcnt(8)
    v_mfma_f32_32x32x16_bf16 v[160:175], a[8:11], a[64:67], v[160:175]
    ds_read_b64_tr_b16 a[26:27], v18 offset:41984
    ds_read_b64_tr_b16 a[28:29], v19 offset:40960
    ds_read_b64_tr_b16 a[30:31], v19 offset:41984
    s_waitcnt lgkmcnt(9)
    v_mfma_f32_32x32x16_bf16 v[176:191], a[12:15], a[64:67], v[176:191]
    s_waitcnt lgkmcnt(0)
    v_mfma_f32_32x32x16_bf16 v[128:143], a[16:19], a[68:71], v[128:143]
    s_cmp_eq_u32 s16, 0
    s_cbranch_scc1 L_wq_34
    s_waitcnt vmcnt(9)
L_wq_34:
    s_waitcnt vmcnt(10)
    s_barrier
    ds_read_b128 a[64:67], v12 offset:57344
    ds_read_b64_tr_b16 a[0:1], v20 offset:0
    ds_read_b64_tr_b16 a[2:3], v20 offset:1024
    v_mfma_f32_32x32x16_bf16 v[144:159], a[20:23], a[68:71], v[144:159]
    s_add_u32 m0, s79, 106496
    s_add_u32 s77, s15, 7340032
    s_and_b32 s77, s77, 8388607
    buffer_load_dwordx4 v6, s[24:27], s77 offen offset:0 lds
    ds_read_b64_tr_b16 a[4:5], v21 offset:0
    ds_read_b64_tr_b16 a[6:7], v21 offset:1024
    ds_read_b64_tr_b16 a[8:9], v22 offset:0
    v_mfma_f32_32x32x16_bf16 v[160:175], a[24:27], a[68:71], v[160:175]
    buffer_load_dwordx4 v7, s[24:27], s77 offen offset:3072 lds
    ds_read_b64_tr_b16 a[10:11], v22 offset:1024
    ds_read_b64_tr_b16 a[12:13], v23 offset:0
    ds_read_b64_tr_b16 a[14:15], v23 offset:1024
    v_mfma_f32_32x32x16_bf16 v[176:191], a[28:31], a[68:71], v[176:191]
    s_add_u32 m0, s79, 112640
    s_nop 0
    buffer_load_dwordx4 v8, s[24:27], s77 offen offset:0 lds
    s_waitcnt lgkmcnt(6)
    v_mfma_f32_32x32x16_bf16 v[128:143], a[0:3], a[64:67], v[128:143]
    ds_read_b128 a[68:71], v13 offset:57344
    ds_read_b64_tr_b16 a[16:17], v20 offset:4096
    ds_read_b64_tr_b16 a[18:19], v20 offset:5120
    buffer_load_dwordx4 v9, s[24:27], s77 offen offset:3072 lds
    s_waitcnt lgkmcnt(7)
    v_mfma_f32_32x32x16_bf16 v[144:159], a[4:7], a[64:67], v[144:159]
    ds_read_b64_tr_b16 a[20:21], v21 offset:4096
    ds_read_b64_tr_b16 a[22:23], v21 offset:5120
    ds_read_b64_tr_b16 a[24:25], v22 offset:4096
    s_add_u32 m0, s79, 118784
    s_nop 0
    buffer_load_dwordx4 v10, s[24:27], s77 offen offset:0 lds
    s_waitcnt lgkmcnt(8)
    v_mfma_f32_32x32x16_bf16 v[160:175], a[8:11], a[64:67], v[160:175]
    ds_read_b64_tr_b16 a[26:27], v22 offset:5120
    ds_read_b64_tr_b16 a[28:29], v23 offset:4096
    ds_read_b64_tr_b16 a[30:31], v23 offset:5120
    s_cmp_lg_u32 s16, 0
    s_cbranch_scc1 L_w0_35
    buffer_load_dwordx4 v11, s[24:27], s77 offen offset:3072 lds
L_w0_35:
    s_waitcnt lgkmcnt(9)
    v_mfma_f32_32x32x16_bf16 v[176:191], a[12:15], a[64:67], v[176:191]
    s_add_u32 m0, s78, 122880
    s_add_u32 s76, s14, 1792
    s_and_b32 s76, s76, 2047
    buffer_load_dwordx4 v2, s[20:23], s76 offen offset:0 lds
    s_waitcnt lgkmcnt(6)
    v_mfma_f32_32x32x16_bf16 v[128:143], a[16:19], a[68:71], v[128:143]
    ds_read_b128 a[64:67], v14 offset:57344
    ds_read_b64_tr_b16 a[0:1], v20 offset:8192
    ds_read_b64_tr_b16 a[2:3], v20 offset:9216
    buffer_load_dwordx4 v3, s[20:23], s76 offen offset:1024 lds
    s_waitcnt lgkmcnt(7)
    v_mfma_f32_32x32x16_bf16 v[144:159], a[20:23], a[68:71], v[144:159]
    ds_read_b64_tr_b16 a[4:5], v21 offset:8192
    ds_read_b64_tr_b16 a[6:7], v21 offset:9216
    ds_read_b64_tr_b16 a[8:9], v22 offset:8192
    buffer_load_dwordx4 v4, s[20:23], s76 offen offset:2048 lds
    s_waitcnt lgkmcnt(8)
    v_mfma_f32_32x32x16_bf16 v[160:175], a[24:27], a[68:71], v[160:175]
    ds_read_b64_tr_b16 a[10:11], v22 offset:9216
    ds_read_b64_tr_b16 a[12:13], v23 offset:8192
    ds_read_b64_tr_b16 a[14:15], v23 offset:9216
    buffer_load_dwordx4 v5, s[20:23], s76 offen offset:3072 lds
    s_waitcnt lgkmcnt(9)
    v_mfma_f32_32x32x16_bf16 v[176:191], a[28:31], a[68:71], v[176:191]
    s_waitcnt lgkmcnt(6)
    v_mfma_f32_32x32x16_bf16 v[128:143], a[0:3], a[64:67], v[128:143]
    ds_read_b128 a[68:71], v15 offset:57344
    ds_read_b64_tr_b16 a[16:17], v20 offset:12288
    ds_read_b64_tr_b16 a[18:19], v20 offset:13312
    s_waitcnt lgkmcnt(7)
    v_mfma_f32_32x32x16_bf16 v[144:159], a[4:7], a[64:67], v[144:159]
    ds_read_b64_tr_b16 a[20:21], v21 offset:12288
    ds_read_b64_tr_b16 a[22:23], v21 offset:13312
    ds_read_b64_tr_b16 a[24:25], v22 offset:12288
    s_waitcnt lgkmcnt(8)
    v_mfma_f32_32x32x16_bf16 v[160:175], a[8:11], a[64:67], v[160:175]
    ds_read_b64_tr_b16 a[26:27], v22 offset:13312
    ds_read_b64_tr_b16 a[28:29], v23 offset:12288
    ds_read_b64_tr_b16 a[30:31], v23 offset:13312
    s_waitcnt lgkmcnt(9)
    v_mfma_f32_32x32x16_bf16 v[176:191], a[12:15], a[64:67], v[176:191]
    s_waitcnt lgkmcnt(0)
    v_mfma_f32_32x32x16_bf16 v[128:143], a[16:19], a[68:71], v[128:143]
    s_cmp_eq_u32 s16, 0
    s_cbranch_scc1 L_wq_36
    s_waitcnt vmcnt(9)
L_wq_36:
    s_waitcnt vmcnt(10)
    s_barrier
    ds_read_b128 a[64:67], v12 offset:0
    ds_read_b64_tr_b16 a[0:1], v16 offset:0
    ds_read_b64_tr_b16 a[2:3], v16 offset:1024
    v_mfma_f32_32x32x16_bf16 v[144:159], a[20:23], a[68:71], v[144:159]
    s_add_u32 m0, s79, 135168
    s_add_u32 s77, s15, 7864320
    s_and_b32 s77, s77, 8388607
    buffer_load_dwordx4 v6, s[24:27], s77 offen offset:0 lds
    ds_read_b64_tr_b16 a[4:5], v17 offset:0
    ds_read_b64_tr_b16 a[6:7], v17 offset:1024
    ds_read_b64_tr_b16 a[8:9], v18 offset:0
    v_mfma_f32_32x32x16_bf16 v[160:175], a[24:27], a[68:71], v[160:175]
    buffer_load_dwordx4 v7, s[24:27], s77 offen offset:3072 lds
    ds_read_b64_tr_b16 a[10:11], v18 offset:1024
    ds_read_b64_tr_b16 a[12:13], v19 offset:0
    ds_read_b64_tr_b16 a[14:15], v19 offset:1024
    v_mfma_f32_32x32x16_bf16 v[176:191], a[28:31], a[68:71], v[176:191]
    s_add_u32 m0, s79, 141312
    s_nop 0
    buffer_load_dwordx4 v8, s[24:27], s77 offen offset:0 lds
    s_waitcnt lgkmcnt(6)
    v_mfma_f32_32x32x16_bf16 v[128:143], a[0:3], a[64:67], v[128:143]
    ds_read_b128 a[68:71], v13 offset:0
    ds_read_b64_tr_b16 a[16:17], v16 offset:4096
    ds_read_b64_tr_b16 a[18:19], v16 offset:5120
    buffer_load_dwordx4 v9, s[24:27], s77 offen offset:3072 lds
    s_waitcnt lgkmcnt(7)
    v_mfma_f32_32x32x16_bf16 v[144:159], a[4:7], a[64:67], v[144:159]
    ds_read_b64_tr_b16 a[20:21], v17 offset:4096
    ds_read_b64_tr_b16 a[22:23], v17 offset:5120
    ds_read_b64_tr_b16 a[24:25], v18 offset:4096
    s_add_u32 m0, s79, 147456
    s_nop 0
    buffer_load_dwordx4 v10, s[24:27], s77 offen offset:0 lds
    s_waitcnt lgkmcnt(8)
    v_mfma_f32_32x32x16_bf16 v[160:175], a[8:11], a[64:67], v[160:175]
    ds_read_b64_tr_b16 a[26:27], v18 offset:5120
    ds_read_b64_tr_b16 a[28:29], v19 offset:4096
    ds_read_b64_tr_b16 a[30:31], v19 offset:5120
    s_cmp_lg_u32 s16, 0
    s_cbranch_scc1 L_w0_37
    buffer_load_dwordx4 v11, s[24:27], s77 offen offset:3072 lds
L_w0_37:
    s_waitcnt lgkmcnt(9)
    v_mfma_f32_32x32x16_bf16 v[176:191], a[12:15], a[64:67], v[176:191]
    s_add_u32 m0, s78, 151552
    s_add_u32 s76, s14, 1920
    s_and_b32 s76, s76, 2047
    buffer_load_dwordx4 v2, s[20:23], s76 offen offset:0 lds
    s_waitcnt lgkmcnt(6)
    v_mfma_f32_32x32x16_bf16 v[128:143], a[16:19], a[68:71], v[128:143]
    ds_read_b128 a[64:67], v14 offset:0
    ds_read_b64_tr_b16 a[0:1], v16 offset:8192
    ds_read_b64_tr_b16 a[2:3], v16 offset:9216
    buffer_load_dwordx4 v3, s[20:23], s76 offen offset:1024 lds
    s_waitcnt lgkmcnt(7)
    v_mfma_f32_32x32x16_bf16 v[144:159], a[20:23], a[68:71], v[144:159]
    ds_read_b64_tr_b16 a[4:5], v17 offset:8192
    ds_read_b64_tr_b16 a[6:7], v17 offset:9216
    ds_read_b64_tr_b16 a[8:9], v18 offset:8192
    buffer_load_dwordx4 v4, s[20:23], s76 offen offset:2048 lds
    s_waitcnt lgkmcnt(8)
    v_mfma_f32_32x32x16_bf16 v[160:175], a[24:27], a[68:71], v[160:175]
    ds_read_b64_tr_b16 a[10:11], v18 offset:9216
    ds_read_b64_tr_b16 a[12:13], v19 offset:8192
    ds_read_b64_tr_b16 a[14:15], v19 offset:9216
    buffer_load_dwordx4 v5, s[20:23], s76 offen offset:3072 lds
    s_waitcnt lgkmcnt(9)
    v_mfma_f32_32x32x16_bf16 v[176:191], a[28:31], a[68:71], v[176:191]
    s_waitcnt lgkmcnt(6)
    v_mfma_f32_32x32x16_bf16 v[128:143], a[0:3], a[64:67], v[128:143]
    ds_read_b128 a[68:71], v15 offset:0
    ds_read_b64_tr_b16 a[16:17], v16 offset:12288
    ds_read_b64_tr_b16 a[18:19], v16 offset:13312
    s_waitcnt lgkmcnt(7)
    v_mfma_f32_32x32x16_bf16 v[144:159], a[4:7], a[64:67], v[144:159]
    ds_read_b64_tr_b16 a[20:21], v17 offset:12288
    ds_read_b64_tr_b16 a[22:23], v17 offset:13312
    ds_read_b64_tr_b16 a[24:25], v18 offset:12288
    s_waitcnt lgkmcnt(8)
    v_mfma_f32_32x32x16_bf16 v[160:175], a[8:11], a[64:67], v[160:175]
    ds_read_b64_tr_b16 a[26:27], v18 offset:13312
    ds_read_b64_tr_b16 a[28:29], v19 offset:12288
    ds_read_b64_tr_b16 a[30:31], v19 offset:13312
    s_waitcnt lgkmcnt(9)
    v_mfma_f32_32x32x16_bf16 v[176:191], a[12:15], a[64:67], v[176:191]
    s_waitcnt lgkmcnt(0)
    v_mfma_f32_32x32x16_bf16 v[128:143], a[16:19], a[68:71], v[128:143]
    s_cmp_eq_u32 s16, 0
    s_cbranch_scc1 L_wq_38
    s_waitcnt vmcnt(9)
L_wq_38:
    s_waitcnt vmcnt(10)
    s_barrier
    ds_read_b128 a[64:67], v12 offset:28672
    ds_read_b64_tr_b16 a[0:1], v16 offset:28672
    ds_read_b64_tr_b16 a[2:3], v16 offset:29696
    v_mfma_f32_32x32x16_bf16 v[144:159], a[20:23], a[68:71], v[144:159]
    ds_read_b64_tr_b16 a[4:5], v17 offset:28672
    ds_read_b64_tr_b16 a[6:7], v17 offset:29696
    ds_read_b64_tr_b16 a[8:9], v18 offset:28672
    v_mfma_f32_32x32x16_bf16 v[160:175], a[24:27], a[68:71], v[160:175]
    ds_read_b64_tr_b16 a[10:11], v18 offset:29696
    ds_read_b64_tr_b16 a[12:13], v19 offset:28672
    ds_read_b64_tr_b16 a[14:15], v19 offset:29696
    v_mfma_f32_32x32x16_bf16 v[176:191], a[28:31], a[68:71], v[176:191]
    s_waitcnt lgkmcnt(6)
    v_mfma_f32_32x32x16_bf16 v[128:143], a[0:3], a[64:67], v[128:143]
    ds_read_b128 a[68:71], v13 offset:28672
    ds_read_b64_tr_b16 a[16:17], v16 offset:32768
    ds_read_b64_tr_b16 a[18:19], v16 offset:33792
    s_waitcnt lgkmcnt(7)
    v_mfma_f32_32x32x16_bf16 v[144:159], a[4:7], a[64:67], v[144:159]
    ds_read_b64_tr_b16 a[20:21], v17 offset:32768
    ds_read_b64_tr_b16 a[22:23], v17 offset:33792
    ds_read_b64_tr_b16 a[24:25], v18 offset:32768
    s_waitcnt lgkmcnt(8)
    v_mfma_f32_32x32x16_bf16 v[160:175], a[8:11], a[64:67], v[160:175]
    ds_read_b64_tr_b16 a[26:27], v18 offset:33792
    ds_read_b64_tr_b16 a[28:29], v19 offset:32768
    ds_read_b64_tr_b16 a[30:31], v19 offset:33792
    s_waitcnt lgkmcnt(9)
    v_mfma_f32_32x32x16_bf16 v[176:191], a[12:15], a[64:67], v[176:191]
    s_waitcnt lgkmcnt(6)
    v_mfma_f32_32x32x16_bf16 v[128:143], a[16:19], a[68:71], v[128:143]
    ds_read_b128 a[64:67], v14 offset:28672
    ds_read_b64_tr_b16 a[0:1], v16 offset:36864
    ds_read_b64_tr_b16 a[2:3], v16 offset:37888
    s_waitcnt lgkmcnt(7)
    v_mfma_f32_32x32x16_bf16 v[144:159], a[20:23], a[68:71], v[144:159]
    ds_read_b64_tr_b16 a[4:5], v17 offset:36864
    ds_read_b64_tr_b16 a[6:7], v17 offset:37888
    ds_read_b64_tr_b16 a[8:9], v18 offset:36864
    s_waitcnt lgkmcnt(8)
    v_mfma_f32_32x32x16_bf16 v[160:175], a[24:27], a[68:71], v[160:175]
    ds_read_b64_tr_b16 a[10:11], v18 offset:37888
    ds_read_b64_tr_b16 a[12:13], v19 offset:36864
    ds_read_b64_tr_b16 a[14:15], v19 offset:37888
    s_waitcnt lgkmcnt(9)
    v_mfma_f32_32x32x16_bf16 v[176:191], a[28:31], a[68:71], v[176:191]
    s_waitcnt lgkmcnt(6)
    v_mfma_f32_32x32x16_bf16 v[128:143], a[0:3], a[64:67], v[128:143]
    ds_read_b128 a[68:71], v15 offset:28672
    ds_read_b64_tr_b16 a[16:17], v16 offset:40960
    ds_read_b64_tr_b16 a[18:19], v16 offset:41984
    s_waitcnt lgkmcnt(7)
    v_mfma_f32_32x32x16_bf16 v[144:159], a[4:7], a[64:67], v[144:159]
    ds_read_b64_tr_b16 a[20:21], v17 offset:40960
    ds_read_b64_tr_b16 a[22:23], v17 offset:41984
    ds_read_b64_tr_b16 a[24:25], v18 offset:40960
    s_waitcnt lgkmcnt(8)
    v_mfma_f32_32x32x16_bf16 v[160:175], a[8:11], a[64:67], v[160:175]
    ds_read_b64_tr_b16 a[26:27], v18 offset:41984
    ds_read_b64_tr_b16 a[28:29], v19 offset:40960
    ds_read_b64_tr_b16 a[30:31], v19 offset:41984
    s_waitcnt lgkmcnt(9)
    v_mfma_f32_32x32x16_bf16 v[176:191], a[12:15], a[64:67], v[176:191]
    s_waitcnt lgkmcnt(0)
    v_mfma_f32_32x32x16_bf16 v[128:143], a[16:19], a[68:71], v[128:143]
    s_waitcnt vmcnt(0)
    s_barrier
    ds_read_b128 a[64:67], v12 offset:57344
    ds_read_b64_tr_b16 a[0:1], v20 offset:0
    ds_read_b64_tr_b16 a[2:3], v20 offset:1024
    v_mfma_f32_32x32x16_bf16 v[144:159], a[20:23], a[68:71], v[144:159]
    ds_read_b64_tr_b16 a[4:5], v21 offset:0
    ds_read_b64_tr_b16 a[6:7], v21 offset:1024
    ds_read_b64_tr_b16 a[8:9], v22 offset:0
    v_mfma_f32_32x32x16_bf16 v[160:175], a[24:27], a[68:71], v[160:175]
    ds_read_b64_tr_b16 a[10:11], v22 offset:1024
    ds_read_b64_tr_b16 a[12:13], v23 offset:0
    ds_read_b64_tr_b16 a[14:15], v23 offset:1024
    v_mfma_f32_32x32x16_bf16 v[176:191], a[28:31], a[68:71], v[176:191]
    s_waitcnt lgkmcnt(6)
    v_mfma_f32_32x32x16_bf16 v[128:143], a[0:3], a[64:67], v[128:143]
    ds_read_b128 a[68:71], v13 offset:57344
    ds_read_b64_tr_b16 a[16:17], v20 offset:4096
    ds_read_b64_tr_b16 a[18:19], v20 offset:5120
    s_waitcnt lgkmcnt(7)
    v_mfma_f32_32x32x16_bf16 v[144:159], a[4:7], a[64:67], v[144:159]
    ds_read_b64_tr_b16 a[20:21], v21 offset:4096
    ds_read_b64_tr_b16 a[22:23], v21 offset:5120
    ds_read_b64_tr_b16 a[24:25], v22 offset:4096
    s_waitcnt lgkmcnt(8)
    v_mfma_f32_32x32x16_bf16 v[160:175], a[8:11], a[64:67], v[160:175]
    ds_read_b64_tr_b16 a[26:27], v22 offset:5120
    ds_read_b64_tr_b16 a[28:29], v23 offset:4096
    ds_read_b64_tr_b16 a[30:31], v23 offset:5120
    s_waitcnt lgkmcnt(9)
    v_mfma_f32_32x32x16_bf16 v[176:191], a[12:15], a[64:67], v[176:191]
    s_waitcnt lgkmcnt(6)
    v_mfma_f32_32x32x16_bf16 v[128:143], a[16:19], a[68:71], v[128:143]
    ds_read_b128 a[64:67], v14 offset:57344
    ds_read_b64_tr_b16 a[0:1], v20 offset:8192
    ds_read_b64_tr_b16 a[2:3], v20 offset:9216
    s_waitcnt lgkmcnt(7)
    v_mfma_f32_32x32x16_bf16 v[144:159], a[20:23], a[68:71], v[144:159]
    ds_read_b64_tr_b16 a[4:5], v21 offset:8192
    ds_read_b64_tr_b16 a[6:7], v21 offset:9216
    ds_read_b64_tr_b16 a[8:9], v22 offset:8192
    s_waitcnt lgkmcnt(8)
    v_mfma_f32_32x32x16_bf16 v[160:175], a[24:27], a[68:71], v[160:175]
    ds_read_b64_tr_b16 a[10:11], v22 offset:9216
    ds_read_b64_tr_b16 a[12:13], v23 offset:8192
    ds_read_b64_tr_b16 a[14:15], v23 offset:9216
    s_waitcnt lgkmcnt(9)
    v_mfma_f32_32x32x16_bf16 v[176:191], a[28:31], a[68:71], v[176:191]
    s_waitcnt lgkmcnt(6)
    v_mfma_f32_32x32x16_bf16 v[128:143], a[0:3], a[64:67], v[128:143]
    ds_read_b128 a[68:71], v15 offset:57344
    ds_read_b64_tr_b16 a[16:17], v20 offset:12288
    ds_read_b64_tr_b16 a[18:19], v20 offset:13312
    s_waitcnt lgkmcnt(7)
    v_mfma_f32_32x32x16_bf16 v[144:159], a[4:7], a[64:67], v[144:159]
    ds_read_b64_tr_b16 a[20:21], v21 offset:12288
    ds_read_b64_tr_b16 a[22:23], v21 offset:13312
    ds_read_b64_tr_b16 a[24:25], v22 offset:12288
    s_waitcnt lgkmcnt(8)
    v_mfma_f32_32x32x16_bf16 v[160:175], a[8:11], a[64:67], v[160:175]
    ds_read_b64_tr_b16 a[26:27], v22 offset:13312
    ds_read_b64_tr_b16 a[28:29], v23 offset:12288
    ds_read_b64_tr_b16 a[30:31], v23 offset:13312
    s_waitcnt lgkmcnt(9)
    v_mfma_f32_32x32x16_bf16 v[176:191], a[12:15], a[64:67], v[176:191]
    s_waitcnt lgkmcnt(0)
    v_mfma_f32_32x32x16_bf16 v[128:143], a[16:19], a[68:71], v[128:143]
    s_barrier
    ds_read_b128 a[32:35], v24 offset:0
    ds_read_b128 a[36:39], v25 offset:0
    ds_read_b128 a[40:43], v26 offset:0
    v_mfma_f32_32x32x16_bf16 v[144:159], a[20:23], a[68:71], v[144:159]
    ds_read_b128 a[44:47], v27 offset:0
    ds_read_b128 a[48:51], v28 offset:0
    ds_read_b128 a[52:55], v29 offset:0
    v_mfma_f32_32x32x16_bf16 v[160:175], a[24:27], a[68:71], v[160:175]
    ds_read_b128 a[56:59], v30 offset:0
    ds_read_b128 a[60:63], v31 offset:0
    v_mfma_f32_32x32x16_bf16 v[176:191], a[28:31], a[68:71], v[176:191]
    v_cvt_pk_bf16_f32 v64, v128, v129
    v_cvt_pk_bf16_f32 v65, v130, v131
    v_cvt_pk_bf16_f32 v66, v132, v133
    v_cvt_pk_bf16_f32 v67, v134, v135
    v_cvt_pk_bf16_f32 v68, v136, v137
    v_cvt_pk_bf16_f32 v69, v138, v139
    v_cvt_pk_bf16_f32 v70, v140, v141
    v_cvt_pk_bf16_f32 v71, v142, v143
    v_cvt_pk_bf16_f32 v72, v144, v145
    v_cvt_pk_bf16_f32 v73, v146, v147
    v_cvt_pk_bf16_f32 v74, v148, v149
    v_cvt_pk_bf16_f32 v75, v150, v151
    v_cvt_pk_bf16_f32 v76, v152, v153
    v_cvt_pk_bf16_f32 v77, v154, v155
    v_cvt_pk_bf16_f32 v78, v156, v157
    v_cvt_pk_bf16_f32 v79, v158, v159
    s_waitcnt lgkmcnt(7)
    v_mfma_f32_32x32x16_bf16 v[96:111], a[32:35], v[64:67], 0
    v_cvt_pk_bf16_f32 v80, v160, v161
    v_cvt_pk_bf16_f32 v81, v162, v163
    v_cvt_pk_bf16_f32 v82, v164, v165
    v_cvt_pk_bf16_f32 v83, v166, v167
    s_waitcnt lgkmcnt(6)
    v_mfma_f32_32x32x16_bf16 v[96:111], a[36:39], v[68:71], v[96:111]
    v_cvt_pk_bf16_f32 v84, v168, v169
    v_cvt_pk_bf16_f32 v85, v170, v171
    v_cvt_pk_bf16_f32 v86, v172, v173
    v_cvt_pk_bf16_f32 v87, v174, v175
    s_waitcnt lgkmcnt(5)
    v_mfma_f32_32x32x16_bf16 v[96:111], a[40:43], v[72:75], v[96:111]
    v_cvt_pk_bf16_f32 v88, v176, v177
    v_cvt_pk_bf16_f32 v89, v178, v179
    v_cvt_pk_bf16_f32 v90, v180, v181
    v_cvt_pk_bf16_f32 v91, v182, v183
    s_waitcnt lgkmcnt(4)
    v_mfma_f32_32x32x16_bf16 v[96:111], a[44:47], v[76:79], v[96:111]
    v_cvt_pk_bf16_f32 v92, v184, v185
    v_cvt_pk_bf16_f32 v93, v186, v187
    v_cvt_pk_bf16_f32 v94, v188, v189
    v_cvt_pk_bf16_f32 v95, v190, v191
    s_waitcnt lgkmcnt(3)
    v_mfma_f32_32x32x16_bf16 v[96:111], a[48:51], v[80:83], v[96:111]
    ds_read_b128 a[0:3], v24 offset:8192
    ds_read_b128 a[4:7], v25 offset:8192
    s_waitcnt lgkmcnt(4)
    v_mfma_f32_32x32x16_bf16 v[96:111], a[52:55], v[84:87], v[96:111]
    ds_read_b128 a[8:11], v26 offset:8192
    ds_read_b128 a[12:15], v27 offset:8192
    s_waitcnt lgkmcnt(5)
    v_mfma_f32_32x32x16_bf16 v[96:111], a[56:59], v[88:91], v[96:111]
    ds_read_b128 a[16:19], v28 offset:8192
    ds_read_b128 a[20:23], v29 offset:8192
    s_waitcnt lgkmcnt(6)
    v_mfma_f32_32x32x16_bf16 v[96:111], a[60:63], v[92:95], v[96:111]
    ds_read_b128 a[24:27], v30 offset:8192
    ds_read_b128 a[28:31], v31 offset:8192
    s_waitcnt lgkmcnt(0)
    v_mfma_f32_32x32x16_bf16 v[112:127], a[0:3], v[64:67], 0
    s_barrier
    ds_read_b128 a[32:35], v24 offset:16384
    ds_read_b128 a[36:39], v25 offset:16384
    ds_read_b128 a[40:43], v26 offset:16384
    v_mfma_f32_32x32x16_bf16 v[112:127], a[4:7], v[68:71], v[112:127]
    ds_read_b128 a[44:47], v27 offset:16384
    ds_read_b128 a[48:51], v28 offset:16384
    ds_read_b128 a[52:55], v29 offset:16384
    v_mfma_f32_32x32x16_bf16 v[112:127], a[8:11], v[72:75], v[112:127]
    ds_read_b128 a[56:59], v30 offset:16384
    ds_read_b128 a[60:63], v31 offset:16384
    v_mfma_f32_32x32x16_bf16 v[112:127], a[12:15], v[76:79], v[112:127]
    v_max3_f32 v56, v56, v96, v97
    v_cvt_pkrtz_f16_f32 v128, v96, v97
    v_max3_f32 v57, v57, v98, v99
    v_cvt_pkrtz_f16_f32 v129, v98, v99
    v_mfma_f32_32x32x16_bf16 v[112:127], a[16:19], v[80:83], v[112:127]
    v_max3_f32 v56, v56, v100, v101
    v_cvt_pkrtz_f16_f32 v130, v100, v101
    v_max3_f32 v57, v57, v102, v103
    v_mfma_f32_32x32x16_bf16 v[112:127], a[20:23], v[84:87], v[112:127]
    v_cvt_pkrtz_f16_f32 v131, v102, v103
    v_max3_f32 v56, v56, v104, v105
    v_cvt_pkrtz_f16_f32 v132, v104, v105
    v_mfma_f32_32x32x16_bf16 v[112:127], a[24:27], v[88:91], v[112:127]
    v_max3_f32 v57, v57, v106, v107
    v_cvt_pkrtz_f16_f32 v133, v106, v107
    v_max3_f32 v56, v56, v108, v109
    v_mfma_f32_32x32x16_bf16 v[112:127], a[28:31], v[92:95], v[112:127]
    v_cvt_pkrtz_f16_f32 v134, v108, v109
    v_max3_f32 v57, v57, v110, v111
    v_cvt_pkrtz_f16_f32 v135, v110, v111
    s_waitcnt lgkmcnt(7)
    v_mfma_f32_32x32x16_bf16 v[96:111], a[32:35], v[64:67], 0
    ds_read_b128 a[0:3], v24 offset:24576
    ds_read_b128 a[4:7], v25 offset:24576
    ds_read_b128 a[8:11], v26 offset:24576
    s_waitcnt lgkmcnt(9)
    v_mfma_f32_32x32x16_bf16 v[96:111], a[36:39], v[68:71], v[96:111]
    ds_read_b128 a[12:15], v27 offset:24576
    ds_read_b128 a[16:19], v28 offset:24576
    ds_read_b128 a[20:23], v29 offset:24576
    s_waitcnt lgkmcnt(11)
    v_mfma_f32_32x32x16_bf16 v[96:111], a[40:43], v[72:75], v[96:111]
    ds_read_b128 a[24:27], v30 offset:24576
    ds_read_b128 a[28:31], v31 offset:24576
    s_waitcnt lgkmcnt(12)
    v_mfma_f32_32x32x16_bf16 v[96:111], a[44:47], v[76:79], v[96:111]
    v_max3_f32 v56, v56, v112, v113
    v_cvt_pkrtz_f16_f32 v136, v112, v113
    v_max3_f32 v57, v57, v114, v115
    v_cvt_pkrtz_f16_f32 v137, v114, v115
    s_waitcnt lgkmcnt(11)
    v_mfma_f32_32x32x16_bf16 v[96:111], a[48:51], v[80:83], v[96:111]
    v_max3_f32 v56, v56, v116, v117
    v_cvt_pkrtz_f16_f32 v138, v116, v117
    v_max3_f32 v57, v57, v118, v119
    s_waitcnt lgkmcnt(10)
    v_mfma_f32_32x32x16_bf16 v[96:111], a[52:55], v[84:87], v[96:111]
    v_cvt_pkrtz_f16_f32 v139, v118, v119
    v_max3_f32 v56, v56, v120, v121
    v_cvt_pkrtz_f16_f32 v140, v120, v121
    s_waitcnt lgkmcnt(9)
    v_mfma_f32_32x32x16_bf16 v[96:111], a[56:59], v[88:91], v[96:111]
    v_max3_f32 v57, v57, v122, v123
    v_cvt_pkrtz_f16_f32 v141, v122, v123
    v_max3_f32 v56, v56, v124, v125
    s_waitcnt lgkmcnt(8)
    v_mfma_f32_32x32x16_bf16 v[96:111], a[60:63], v[92:95], v[96:111]
    v_cvt_pkrtz_f16_f32 v142, v124, v125
    v_max3_f32 v57, v57, v126, v127
    v_cvt_pkrtz_f16_f32 v143, v126, v127
    s_waitcnt lgkmcnt(0)
    v_mfma_f32_32x32x16_bf16 v[112:127], a[0:3], v[64:67], 0
    s_barrier
    ds_read_b128 a[32:35], v24 offset:32768
    ds_read_b128 a[36:39], v25 offset:32768
    ds_read_b128 a[40:43], v26 offset:32768
    v_mfma_f32_32x32x16_bf16 v[112:127], a[4:7], v[68:71], v[112:127]
    ds_read_b128 a[44:47], v27 offset:32768
    ds_read_b128 a[48:51], v28 offset:32768
    ds_read_b128 a[52:55], v29 offset:32768
    v_mfma_f32_32x32x16_bf16 v[112:127], a[8:11], v[72:75], v[112:127]
    ds_read_b128 a[56:59], v30 offset:32768
    ds_read_b128 a[60:63], v31 offset:32768
    v_mfma_f32_32x32x16_bf16 v[112:127], a[12:15], v[76:79], v[112:127]
    v_max3_f32 v56, v56, v96, v97
    v_cvt_pkrtz_f16_f32 v144, v96, v97
    v_max3_f32 v57, v57, v98, v99
    v_cvt_pkrtz_f16_f32 v145, v98, v99
    v_mfma_f32_32x32x16_bf16 v[112:127], a[16:19], v[80:83], v[112:127]
    v_max3_f32 v56, v56, v100, v101
    v_cvt_pkrtz_f16_f32 v146, v100, v101
    v_max3_f32 v57, v57, v102, v103
    v_mfma_f32_32x32x16_bf16 v[112:127], a[20:23], v[84:87], v[112:127]
    v_cvt_pkrtz_f16_f32 v147, v102, v103
    v_max3_f32 v56, v56, v104, v105
    v_cvt_pkrtz_f16_f32 v148, v104, v105
    v_mfma_f32_32x32x16_bf16 v[112:127], a[24:27], v[88:91], v[112:127]
    v_max3_f32 v57, v57, v106, v107
    v_cvt_pkrtz_f16_f32 v149, v106, v107
    v_max3_f32 v56, v56, v108, v109
    v_mfma_f32_32x32x16_bf16 v[112:127], a[28:31], v[92:95], v[112:127]
    v_cvt_pkrtz_f16_f32 v150, v108, v109
    v_max3_f32 v57, v57, v110, v111
    v_cvt_pkrtz_f16_f32 v151, v110, v111
    s_waitcnt lgkmcnt(7)
    v_mfma_f32_32x32x16_bf16 v[96:111], a[32:35], v[64:67], 0
    ds_read_b128 a[0:3], v24 offset:40960
    ds_read_b128 a[4:7], v25 offset:40960
    ds_read_b128 a[8:11], v26 offset:40960
    s_waitcnt lgkmcnt(9)
    v_mfma_f32_32x32x16_bf16 v[96:111], a[36:39], v[68:71], v[96:111]
    ds_read_b128 a[12:15], v27 offset:40960
    ds_read_b128 a[16:19], v28 offset:40960
    ds_read_b128 a[20:23], v29 offset:40960
    s_waitcnt lgkmcnt(11)
    v_mfma_f32_32x32x16_bf16 v[96:111], a[40:43], v[72:75], v[96:111]
    ds_read_b128 a[24:27], v30 offset:40960
    ds_read_b128 a[28:31], v31 offset:40960
    s_waitcnt lgkmcnt(12)
    v_mfma_f32_32x32x16_bf16 v[96:111], a[44:47], v[76:79], v[96:111]
    v_max3_f32 v56, v56, v112, v113
    v_cvt_pkrtz_f16_f32 v152, v112, v113
    v_max3_f32 v57, v57, v114, v115
    v_cvt_pkrtz_f16_f32 v153, v114, v115
    s_waitcnt lgkmcnt(11)
    v_mfma_f32_32x32x16_bf16 v[96:111], a[48:51], v[80:83], v[96:111]
    v_max3_f32 v56, v56, v116, v117
    v_cvt_pkrtz_f16_f32 v154, v116, v117
    v_max3_f32 v57, v57, v118, v119
    s_waitcnt lgkmcnt(10)
    v_mfma_f32_32x32x16_bf16 v[96:111], a[52:55], v[84:87], v[96:111]
    v_cvt_pkrtz_f16_f32 v155, v118, v119
    v_max3_f32 v56, v56, v120, v121
    v_cvt_pkrtz_f16_f32 v156, v120, v121
    s_waitcnt lgkmcnt(9)
    v_mfma_f32_32x32x16_bf16 v[96:111], a[56:59], v[88:91], v[96:111]
    v_max3_f32 v57, v57, v122, v123
    v_cvt_pkrtz_f16_f32 v157, v122, v123
    v_max3_f32 v56, v56, v124, v125
    s_waitcnt lgkmcnt(8)
    v_mfma_f32_32x32x16_bf16 v[96:111], a[60:63], v[92:95], v[96:111]
    v_cvt_pkrtz_f16_f32 v158, v124, v125
    v_max3_f32 v57, v57, v126, v127
    v_cvt_pkrtz_f16_f32 v159, v126, v127
    s_waitcnt lgkmcnt(0)
    v_mfma_f32_32x32x16_bf16 v[112:127], a[0:3], v[64:67], 0
    s_barrier
    ds_read_b128 a[32:35], v24 offset:49152
    ds_read_b128 a[36:39], v25 offset:49152
    ds_read_b128 a[40:43], v26 offset:49152
    v_mfma_f32_32x32x16_bf16 v[112:127], a[4:7], v[68:71], v[112:127]
    ds_read_b128 a[44:47], v27 offset:49152
    ds_read_b128 a[48:51], v28 offset:49152
    ds_read_b128 a[52:55], v29 offset:49152
    v_mfma_f32_32x32x16_bf16 v[112:127], a[8:11], v[72:75], v[112:127]
    ds_read_b128 a[56:59], v30 offset:49152
    ds_read_b128 a[60:63], v31 offset:49152
    v_mfma_f32_32x32x16_bf16 v[112:127], a[12:15], v[76:79], v[112:127]
    v_max3_f32 v56, v56, v96, v97
    v_cvt_pkrtz_f16_f32 v160, v96, v97
    v_max3_f32 v57, v57, v98, v99
    v_cvt_pkrtz_f16_f32 v161, v98, v99
    v_mfma_f32_32x32x16_bf16 v[112:127], a[16:19], v[80:83], v[112:127]
    v_max3_f32 v56, v56, v100, v101
    v_cvt_pkrtz_f16_f32 v162, v100, v101
    v_max3_f32 v57, v57, v102, v103
    v_mfma_f32_32x32x16_bf16 v[112:127], a[20:23], v[84:87], v[112:127]
    v_cvt_pkrtz_f16_f32 v163, v102, v103
    v_max3_f32 v56, v56, v104, v105
    v_cvt_pkrtz_f16_f32 v164, v104, v105
    v_mfma_f32_32x32x16_bf16 v[112:127], a[24:27], v[88:91], v[112:127]
    v_max3_f32 v57, v57, v106, v107
    v_cvt_pkrtz_f16_f32 v165, v106, v107
    v_max3_f32 v56, v56, v108, v109
    v_mfma_f32_32x32x16_bf16 v[112:127], a[28:31], v[92:95], v[112:127]
    v_cvt_pkrtz_f16_f32 v166, v108, v109
    v_max3_f32 v57, v57, v110, v111
    v_cvt_pkrtz_f16_f32 v167, v110, v111
    s_waitcnt lgkmcnt(7)
    v_mfma_f32_32x32x16_bf16 v[96:111], a[32:35], v[64:67], 0
    ds_read_b128 a[0:3], v24 offset:57344
    ds_read_b128 a[4:7], v25 offset:57344
    ds_read_b128 a[8:11], v26 offset:57344
    s_waitcnt lgkmcnt(9)
    v_mfma_f32_32x32x16_bf16 v[96:111], a[36:39], v[68:71], v[96:111]
    ds_read_b128 a[12:15], v27 offset:57344
    ds_read_b128 a[16:19], v28 offset:57344
    ds_read_b128 a[20:23], v29 offset:57344
    s_waitcnt lgkmcnt(11)
    v_mfma_f32_32x32x16_bf16 v[96:111], a[40:43], v[72:75], v[96:111]
    ds_read_b128 a[24:27], v30 offset:57344
    ds_read_b128 a[28:31], v31 offset:57344
    s_waitcnt lgkmcnt(12)
    v_mfma_f32_32x32x16_bf16 v[96:111], a[44:47], v[76:79], v[96:111]
    v_max3_f32 v56, v56, v112, v113
    v_cvt_pkrtz_f16_f32 v168, v112, v113
    v_max3_f32 v57, v57, v114, v115
    v_cvt_pkrtz_f16_f32 v169, v114, v115
    s_waitcnt lgkmcnt(11)
    v_mfma_f32_32x32x16_bf16 v[96:111], a[48:51], v[80:83], v[96:111]
    v_max3_f32 v56, v56, v116, v117
    v_cvt_pkrtz_f16_f32 v170, v116, v117
    v_max3_f32 v57, v57, v118, v119
    s_waitcnt lgkmcnt(10)
    v_mfma_f32_32x32x16_bf16 v[96:111], a[52:55], v[84:87], v[96:111]
    v_cvt_pkrtz_f16_f32 v171, v118, v119
    v_max3_f32 v56, v56, v120, v121
    v_cvt_pkrtz_f16_f32 v172, v120, v121
    s_waitcnt lgkmcnt(9)
    v_mfma_f32_32x32x16_bf16 v[96:111], a[56:59], v[88:91], v[96:111]
    v_max3_f32 v57, v57, v122, v123
    v_cvt_pkrtz_f16_f32 v173, v122, v123
    v_max3_f32 v56, v56, v124, v125
    s_waitcnt lgkmcnt(8)
    v_mfma_f32_32x32x16_bf16 v[96:111], a[60:63], v[92:95], v[96:111]
    v_cvt_pkrtz_f16_f32 v174, v124, v125
    v_max3_f32 v57, v57, v126, v127
    v_cvt_pkrtz_f16_f32 v175, v126, v127
    s_waitcnt lgkmcnt(0)
    v_mfma_f32_32x32x16_bf16 v[112:127], a[0:3], v[64:67], 0
    s_barrier
    v_add_u32 v24, 65536, v24
    v_add_u32 v25, 65536, v25
    v_add_u32 v26, 65536, v26
    v_add_u32 v27, 65536, v27
    v_mfma_f32_32x32x16_bf16 v[112:127], a[4:7], v[68:71], v[112:127]
    v_add_u32 v28, 65536, v28
    v_add_u32 v29, 65536, v29
    v_add_u32 v30, 65536, v30
    v_add_u32 v31, 65536, v31
    v_mfma_f32_32x32x16_bf16 v[112:127], a[8:11], v[72:75], v[112:127]
    ds_read_b128 a[32:35], v24 offset:0
    ds_read_b128 a[36:39], v25 offset:0
    ds_read_b128 a[40:43], v26 offset:0
    ds_read_b128 a[44:47], v27 offset:0
    v_mfma_f32_32x32x16_bf16 v[112:127], a[12:15], v[76:79], v[112:127]
    ds_read_b128 a[48:51], v28 offset:0
    ds_read_b128 a[52:55], v29 offset:0
    ds_read_b128 a[56:59], v30 offset:0
    ds_read_b128 a[60:63], v31 offset:0
    v_mfma_f32_32x32x16_bf16 v[112:127], a[16:19], v[80:83], v[112:127]
    v_max3_f32 v56, v56, v96, v97
    v_cvt_pkrtz_f16_f32 v176, v96, v97
    v_max3_f32 v57, v57, v98, v99
    v_cvt_pkrtz_f16_f32 v177, v98, v99
    v_mfma_f32_32x32x16_bf16 v[112:127], a[20:23], v[84:87], v[112:127]
    v_max3_f32 v56, v56, v100, v101
    v_cvt_pkrtz_f16_f32 v178, v100, v101
    v_max3_f32 v57, v57, v102, v103
    v_cvt_pkrtz_f16_f32 v179, v102, v103
    v_mfma_f32_32x32x16_bf16 v[112:127], a[24:27], v[88:91], v[112:127]
    v_max3_f32 v56, v56, v104, v105
    v_cvt_pkrtz_f16_f32 v180, v104, v105
    v_max3_f32 v57, v57, v106, v107
    v_cvt_pkrtz_f16_f32 v181, v106, v107
    v_mfma_f32_32x32x16_bf16 v[112:127], a[28:31], v[92:95], v[112:127]
    v_max3_f32 v56, v56, v108, v109
    v_cvt_pkrtz_f16_f32 v182, v108, v109
    v_max3_f32 v57, v57, v110, v111
    v_cvt_pkrtz_f16_f32 v183, v110, v111
    s_waitcnt lgkmcnt(7)
    v_mfma_f32_32x32x16_bf16 v[96:111], a[32:35], v[64:67], 0
    ds_read_b128 a[0:3], v24 offset:8192
    ds_read_b128 a[4:7], v25 offset:8192
    ds_read_b128 a[8:11], v26 offset:8192
    s_waitcnt lgkmcnt(9)
    v_mfma_f32_32x32x16_bf16 v[96:111], a[36:39], v[68:71], v[96:111]
    ds_read_b128 a[12:15], v27 offset:8192
    ds_read_b128 a[16:19], v28 offset:8192
    ds_read_b128 a[20:23], v29 offset:8192
    s_waitcnt lgkmcnt(11)
    v_mfma_f32_32x32x16_bf16 v[96:111], a[40:43], v[72:75], v[96:111]
    ds_read_b128 a[24:27], v30 offset:8192
    ds_read_b128 a[28:31], v31 offset:8192
    s_waitcnt lgkmcnt(12)
    v_mfma_f32_32x32x16_bf16 v[96:111], a[44:47], v[76:79], v[96:111]
    v_max3_f32 v56, v56, v112, v113
    v_cvt_pkrtz_f16_f32 v184, v112, v113
    v_max3_f32 v57, v57, v114, v115
    v_cvt_pkrtz_f16_f32 v185, v114, v115
    s_waitcnt lgkmcnt(11)
    v_mfma_f32_32x32x16_bf16 v[96:111], a[48:51], v[80:83], v[96:111]
    v_max3_f32 v56, v56, v116, v117
    v_cvt_pkrtz_f16_f32 v186, v116, v117
    v_max3_f32 v57, v57, v118, v119
    s_waitcnt lgkmcnt(10)
    v_mfma_f32_32x32x16_bf16 v[96:111], a[52:55], v[84:87], v[96:111]
    v_cvt_pkrtz_f16_f32 v187, v118, v119
    v_max3_f32 v56, v56, v120, v121
    v_cvt_pkrtz_f16_f32 v188, v120, v121
    s_waitcnt lgkmcnt(9)
    v_mfma_f32_32x32x16_bf16 v[96:111], a[56:59], v[88:91], v[96:111]
    v_max3_f32 v57, v57, v122, v123
    v_cvt_pkrtz_f16_f32 v189, v122, v123
    v_max3_f32 v56, v56, v124, v125
    s_waitcnt lgkmcnt(8)
    v_mfma_f32_32x32x16_bf16 v[96:111], a[60:63], v[92:95], v[96:111]
    v_cvt_pkrtz_f16_f32 v190, v124, v125
    v_max3_f32 v57, v57, v126, v127
    v_cvt_pkrtz_f16_f32 v191, v126, v127
    s_waitcnt lgkmcnt(0)
    v_mfma_f32_32x32x16_bf16 v[112:127], a[0:3], v[64:67], 0
    s_barrier
    ds_read_b128 a[32:35], v24 offset:16384
    ds_read_b128 a[36:39], v25 offset:16384
    ds_read_b128 a[40:43], v26 offset:16384
    v_mfma_f32_32x32x16_bf16 v[112:127], a[4:7], v[68:71], v[112:127]
    ds_read_b128 a[44:47], v27 offset:16384
    ds_read_b128 a[48:51], v28 offset:16384
    ds_read_b128 a[52:55], v29 offset:16384
    v_mfma_f32_32x32x16_bf16 v[112:127], a[8:11], v[72:75], v[112:127]
    ds_read_b128 a[56:59], v30 offset:16384
    ds_read_b128 a[60:63], v31 offset:16384
    v_mfma_f32_32x32x16_bf16 v[112:127], a[12:15], v[76:79], v[112:127]
    v_max3_f32 v56, v56, v96, v97
    v_cvt_pkrtz_f16_f32 v192, v96, v97
    v_max3_f32 v57, v57, v98, v99
    v_cvt_pkrtz_f16_f32 v193, v98, v99
    v_mfma_f32_32x32x16_bf16 v[112:127], a[16:19], v[80:83], v[112:127]
    v_max3_f32 v56, v56, v100, v101
    v_cvt_pkrtz_f16_f32 v194, v100, v101
    v_max3_f32 v57, v57, v102, v103
    v_mfma_f32_32x32x16_bf16 v[112:127], a[20:23], v[84:87], v[112:127]
    v_cvt_pkrtz_f16_f32 v195, v102, v103
    v_max3_f32 v56, v56, v104, v105
    v_cvt_pkrtz_f16_f32 v196, v104, v105
    v_mfma_f32_32x32x16_bf16 v[112:127], a[24:27], v[88:91], v[112:127]
    v_max3_f32 v57, v57, v106, v107
    v_cvt_pkrtz_f16_f32 v197, v106, v107
    v_max3_f32 v56, v56, v108, v109
    v_mfma_f32_32x32x16_bf16 v[112:127], a[28:31], v[92:95], v[112:127]
    v_cvt_pkrtz_f16_f32 v198, v108, v109
    v_max3_f32 v57, v57, v110, v111
    v_cvt_pkrtz_f16_f32 v199, v110, v111
    s_waitcnt lgkmcnt(7)
    v_mfma_f32_32x32x16_bf16 v[96:111], a[32:35], v[64:67], 0
    ds_read_b128 a[0:3], v24 offset:24576
    ds_read_b128 a[4:7], v25 offset:24576
    ds_read_b128 a[8:11], v26 offset:24576
    s_waitcnt lgkmcnt(9)
    v_mfma_f32_32x32x16_bf16 v[96:111], a[36:39], v[68:71], v[96:111]
    ds_read_b128 a[12:15], v27 offset:24576
    ds_read_b128 a[16:19], v28 offset:24576
    ds_read_b128 a[20:23], v29 offset:24576
    s_waitcnt lgkmcnt(11)
    v_mfma_f32_32x32x16_bf16 v[96:111], a[40:43], v[72:75], v[96:111]
    ds_read_b128 a[24:27], v30 offset:24576
    ds_read_b128 a[28:31], v31 offset:24576
    s_waitcnt lgkmcnt(12)
    v_mfma_f32_32x32x16_bf16 v[96:111], a[44:47], v[76:79], v[96:111]
    v_max3_f32 v56, v56, v112, v113
    v_cvt_pkrtz_f16_f32 v200, v112, v113
    v_max3_f32 v57, v57, v114, v115
    v_cvt_pkrtz_f16_f32 v201, v114, v115
    s_waitcnt lgkmcnt(11)
    v_mfma_f32_32x32x16_bf16 v[96:111], a[48:51], v[80:83], v[96:111]
    v_max3_f32 v56, v56, v116, v117
    v_cvt_pkrtz_f16_f32 v202, v116, v117
    v_max3_f32 v57, v57, v118, v119
    s_waitcnt lgkmcnt(10)
    v_mfma_f32_32x32x16_bf16 v[96:111], a[52:55], v[84:87], v[96:111]
    v_cvt_pkrtz_f16_f32 v203, v118, v119
    v_max3_f32 v56, v56, v120, v121
    v_cvt_pkrtz_f16_f32 v204, v120, v121
    s_waitcnt lgkmcnt(9)
    v_mfma_f32_32x32x16_bf16 v[96:111], a[56:59], v[88:91], v[96:111]
    v_max3_f32 v57, v57, v122, v123
    v_cvt_pkrtz_f16_f32 v205, v122, v123
    v_max3_f32 v56, v56, v124, v125
    s_waitcnt lgkmcnt(8)
    v_mfma_f32_32x32x16_bf16 v[96:111], a[60:63], v[92:95], v[96:111]
    v_cvt_pkrtz_f16_f32 v206, v124, v125
    v_max3_f32 v57, v57, v126, v127
    v_cvt_pkrtz_f16_f32 v207, v126, v127
    s_waitcnt lgkmcnt(0)
    v_mfma_f32_32x32x16_bf16 v[112:127], a[0:3], v[64:67], 0
    s_barrier
    ds_read_b128 a[32:35], v24 offset:32768
    ds_read_b128 a[36:39], v25 offset:32768
    ds_read_b128 a[40:43], v26 offset:32768
    v_mfma_f32_32x32x16_bf16 v[112:127], a[4:7], v[68:71], v[112:127]
    ds_read_b128 a[44:47], v27 offset:32768
    ds_read_b128 a[48:51], v28 offset:32768
    ds_read_b128 a[52:55], v29 offset:32768
    v_mfma_f32_32x32x16_bf16 v[112:127], a[8:11], v[72:75], v[112:127]
    ds_read_b128 a[56:59], v30 offset:32768
    ds_read_b128 a[60:63], v31 offset:32768
    v_mfma_f32_32x32x16_bf16 v[112:127], a[12:15], v[76:79], v[112:127]
    v_max3_f32 v56, v56, v96, v97
    v_cvt_pkrtz_f16_f32 v208, v96, v97
    v_max3_f32 v57, v57, v98, v99
    v_cvt_pkrtz_f16_f32 v209, v98, v99
    v_mfma_f32_32x32x16_bf16 v[112:127], a[16:19], v[80:83], v[112:127]
    v_max3_f32 v56, v56, v100, v101
    v_cvt_pkrtz_f16_f32 v210, v100, v101
    v_max3_f32 v57, v57, v102, v103
    v_mfma_f32_32x32x16_bf16 v[112:127], a[20:23], v[84:87], v[112:127]
    v_cvt_pkrtz_f16_f32 v211, v102, v103
    v_max3_f32 v56, v56, v104, v105
    v_cvt_pkrtz_f16_f32 v212, v104, v105
    v_mfma_f32_32x32x16_bf16 v[112:127], a[24:27], v[88:91], v[112:127]
    v_max3_f32 v57, v57, v106, v107
    v_cvt_pkrtz_f16_f32 v213, v106, v107
    v_max3_f32 v56, v56, v108, v109
    v_mfma_f32_32x32x16_bf16 v[112:127], a[28:31], v[92:95], v[112:127]
    v_cvt_pkrtz_f16_f32 v214, v108, v109
    v_max3_f32 v57, v57, v110, v111
    v_cvt_pkrtz_f16_f32 v215, v110, v111
    s_waitcnt lgkmcnt(7)
    v_mfma_f32_32x32x16_bf16 v[96:111], a[32:35], v[64:67], 0
    ds_read_b128 a[0:3], v24 offset:40960
    ds_read_b128 a[4:7], v25 offset:40960
    ds_read_b128 a[8:11], v26 offset:40960
    s_waitcnt lgkmcnt(9)
    v_mfma_f32_32x32x16_bf16 v[96:111], a[36:39], v[68:71], v[96:111]
    ds_read_b128 a[12:15], v27 offset:40960
    ds_read_b128 a[16:19], v28 offset:40960
    ds_read_b128 a[20:23], v29 offset:40960
    s_waitcnt lgkmcnt(11)
    v_mfma_f32_32x32x16_bf16 v[96:111], a[40:43], v[72:75], v[96:111]
    ds_read_b128 a[24:27], v30 offset:40960
    ds_read_b128 a[28:31], v31 offset:40960
    s_waitcnt lgkmcnt(12)
    v_mfma_f32_32x32x16_bf16 v[96:111], a[44:47], v[76:79], v[96:111]
    v_max3_f32 v56, v56, v112, v113
    v_cvt_pkrtz_f16_f32 v216, v112, v113
    v_max3_f32 v57, v57, v114, v115
    v_cvt_pkrtz_f16_f32 v217, v114, v115
    s_waitcnt lgkmcnt(11)
    v_mfma_f32_32x32x16_bf16 v[96:111], a[48:51], v[80:83], v[96:111]
    v_max3_f32 v56, v56, v116, v117
    v_cvt_pkrtz_f16_f32 v218, v116, v117
    v_max3_f32 v57, v57, v118, v119
    s_waitcnt lgkmcnt(10)
    v_mfma_f32_32x32x16_bf16 v[96:111], a[52:55], v[84:87], v[96:111]
    v_cvt_pkrtz_f16_f32 v219, v118, v119
    v_max3_f32 v56, v56, v120, v121
    v_cvt_pkrtz_f16_f32 v220, v120, v121
    s_waitcnt lgkmcnt(9)
    v_mfma_f32_32x32x16_bf16 v[96:111], a[56:59], v[88:91], v[96:111]
    v_max3_f32 v57, v57, v122, v123
    v_cvt_pkrtz_f16_f32 v221, v122, v123
    v_max3_f32 v56, v56, v124, v125
    s_waitcnt lgkmcnt(8)
    v_mfma_f32_32x32x16_bf16 v[96:111], a[60:63], v[92:95], v[96:111]
    v_cvt_pkrtz_f16_f32 v222, v124, v125
    v_max3_f32 v57, v57, v126, v127
    v_cvt_pkrtz_f16_f32 v223, v126, v127
    s_waitcnt lgkmcnt(0)
    v_mfma_f32_32x32x16_bf16 v[112:127], a[0:3], v[64:67], 0
    s_barrier
    ds_read_b128 a[32:35], v24 offset:49152
    ds_read_b128 a[36:39], v25 offset:49152
    ds_read_b128 a[40:43], v26 offset:49152
    v_mfma_f32_32x32x16_bf16 v[112:127], a[4:7], v[68:71], v[112:127]
    ds_read_b128 a[44:47], v27 offset:49152
    ds_read_b128 a[48:51], v28 offset:49152
    ds_read_b128 a[52:55], v29 offset:49152
    v_mfma_f32_32x32x16_bf16 v[112:127], a[8:11], v[72:75], v[112:127]
    ds_read_b128 a[56:59], v30 offset:49152
    ds_read_b128 a[60:63], v31 offset:49152
    v_mfma_f32_32x32x16_bf16 v[112:127], a[12:15], v[76:79], v[112:127]
    v_max3_f32 v56, v56, v96, v97
    v_cvt_pkrtz_f16_f32 v224, v96, v97
    v_max3_f32 v57, v57, v98, v99
    v_cvt_pkrtz_f16_f32 v225, v98, v99
    v_mfma_f32_32x32x16_bf16 v[112:127], a[16:19], v[80:83], v[112:127]
    v_max3_f32 v56, v56, v100, v101
    v_cvt_pkrtz_f16_f32 v226, v100, v101
    v_max3_f32 v57, v57, v102, v103
    v_mfma_f32_32x32x16_bf16 v[112:127], a[20:23], v[84:87], v[112:127]
    v_cvt_pkrtz_f16_f32 v227, v102, v103
    v_max3_f32 v56, v56, v104, v105
    v_cvt_pkrtz_f16_f32 v228, v104, v105
    v_mfma_f32_32x32x16_bf16 v[112:127], a[24:27], v[88:91], v[112:127]
    v_max3_f32 v57, v57, v106, v107
    v_cvt_pkrtz_f16_f32 v229, v106, v107
    v_max3_f32 v56, v56, v108, v109
    v_mfma_f32_32x32x16_bf16 v[112:127], a[28:31], v[92:95], v[112:127]
    v_cvt_pkrtz_f16_f32 v230, v108, v109
    v_max3_f32 v57, v57, v110, v111
    v_cvt_pkrtz_f16_f32 v231, v110, v111
    s_waitcnt lgkmcnt(7)
    v_mfma_f32_32x32x16_bf16 v[96:111], a[32:35], v[64:67], 0
    ds_read_b128 a[0:3], v24 offset:57344
    ds_read_b128 a[4:7], v25 offset:57344
    ds_read_b128 a[8:11], v26 offset:57344
    s_waitcnt lgkmcnt(9)
    v_mfma_f32_32x32x16_bf16 v[96:111], a[36:39], v[68:71], v[96:111]
    ds_read_b128 a[12:15], v27 offset:57344
    ds_read_b128 a[16:19], v28 offset:57344
    ds_read_b128 a[20:23], v29 offset:57344
    s_waitcnt lgkmcnt(11)
    v_mfma_f32_32x32x16_bf16 v[96:111], a[40:43], v[72:75], v[96:111]
    ds_read_b128 a[24:27], v30 offset:57344
    ds_read_b128 a[28:31], v31 offset:57344
    s_waitcnt lgkmcnt(12)
    v_mfma_f32_32x32x16_bf16 v[96:111], a[44:47], v[76:79], v[96:111]
    v_max3_f32 v56, v56, v112, v113
    v_cvt_pkrtz_f16_f32 v232, v112, v113
    v_max3_f32 v57, v57, v114, v115
    v_cvt_pkrtz_f16_f32 v233, v114, v115
    s_waitcnt lgkmcnt(11)
    v_mfma_f32_32x32x16_bf16 v[96:111], a[48:51], v[80:83], v[96:111]
    v_max3_f32 v56, v56, v116, v117
    v_cvt_pkrtz_f16_f32 v234, v116, v117
    v_max3_f32 v57, v57, v118, v119
    s_waitcnt lgkmcnt(10)
    v_mfma_f32_32x32x16_bf16 v[96:111], a[52:55], v[84:87], v[96:111]
    v_cvt_pkrtz_f16_f32 v235, v118, v119
    v_max3_f32 v56, v56, v120, v121
    v_cvt_pkrtz_f16_f32 v236, v120, v121
    s_waitcnt lgkmcnt(9)
    v_mfma_f32_32x32x16_bf16 v[96:111], a[56:59], v[88:91], v[96:111]
    v_max3_f32 v57, v57, v122, v123
    v_cvt_pkrtz_f16_f32 v237, v122, v123
    v_max3_f32 v56, v56, v124, v125
    s_waitcnt lgkmcnt(8)
    v_mfma_f32_32x32x16_bf16 v[96:111], a[60:63], v[92:95], v[96:111]
    v_cvt_pkrtz_f16_f32 v238, v124, v125
    v_max3_f32 v57, v57, v126, v127
    v_cvt_pkrtz_f16_f32 v239, v126, v127
    s_waitcnt lgkmcnt(7)
    v_mfma_f32_32x32x16_bf16 v[112:127], a[0:3], v[64:67], 0
    s_waitcnt lgkmcnt(6)
    v_mfma_f32_32x32x16_bf16 v[112:127], a[4:7], v[68:71], v[112:127]
    s_waitcnt lgkmcnt(5)
    v_mfma_f32_32x32x16_bf16 v[112:127], a[8:11], v[72:75], v[112:127]
    s_waitcnt lgkmcnt(4)
    v_mfma_f32_32x32x16_bf16 v[112:127], a[12:15], v[76:79], v[112:127]
    s_nop 0
    v_max3_f32 v56, v56, v96, v97
    v_cvt_pkrtz_f16_f32 v240, v96, v97
    v_max3_f32 v57, v57, v98, v99
    v_cvt_pkrtz_f16_f32 v241, v98, v99
    s_waitcnt lgkmcnt(3)
    v_mfma_f32_32x32x16_bf16 v[112:127], a[16:19], v[80:83], v[112:127]
    v_max3_f32 v56, v56, v100, v101
    v_cvt_pkrtz_f16_f32 v242, v100, v101
    v_max3_f32 v57, v57, v102, v103
    s_waitcnt lgkmcnt(2)
    v_mfma_f32_32x32x16_bf16 v[112:127], a[20:23], v[84:87], v[112:127]
    v_cvt_pkrtz_f16_f32 v243, v102, v103
    v_max3_f32 v56, v56, v104, v105
    v_cvt_pkrtz_f16_f32 v244, v104, v105
    s_waitcnt lgkmcnt(1)
    v_mfma_f32_32x32x16_bf16 v[112:127], a[24:27], v[88:91], v[112:127]
    v_max3_f32 v57, v57, v106, v107
    v_cvt_pkrtz_f16_f32 v245, v106, v107
    v_max3_f32 v56, v56, v108, v109
    s_waitcnt lgkmcnt(0)
    v_mfma_f32_32x32x16_bf16 v[112:127], a[28:31], v[92:95], v[112:127]
    v_cvt_pkrtz_f16_f32 v246, v108, v109
    v_max3_f32 v57, v57, v110, v111
    v_cvt_pkrtz_f16_f32 v247, v110, v111
    s_nop 8
    v_max3_f32 v56, v56, v112, v113
    v_cvt_pkrtz_f16_f32 v248, v112, v113
    v_max3_f32 v57, v57, v114, v115
    v_cvt_pkrtz_f16_f32 v249, v114, v115
    v_max3_f32 v56, v56, v116, v117
    v_cvt_pkrtz_f16_f32 v250, v116, v117
    v_max3_f32 v57, v57, v118, v119
    v_cvt_pkrtz_f16_f32 v251, v118, v119
    v_max3_f32 v56, v56, v120, v121
    v_cvt_pkrtz_f16_f32 v252, v120, v121
    v_max3_f32 v57, v57, v122, v123
    v_cvt_pkrtz_f16_f32 v253, v122, v123
    v_max3_f32 v56, v56, v124, v125
    v_cvt_pkrtz_f16_f32 v254, v124, v125
    v_max3_f32 v57, v57, v126, v127
    v_cvt_pkrtz_f16_f32 v255, v126, v127
    v_max_f32 v56, v56, v57
    v_mov_b32 v57, v56
    s_nop 1
    v_permlane32_swap_b32 v56, v57
    v_max_f32 v56, v56, v57
    v_cvt_pkrtz_f16_f32 v56, v56, v56
    v_cvt_f32_f16 v56, v56
    v_mul_f32 v58, s82, v56
    v_fma_mix_f32 v44, v128, s82, -v58 op_sel:[0,0,0] op_sel_hi:[1,0,0]
    v_fma_mix_f32 v45, v128, s82, -v58 op_sel:[1,0,0] op_sel_hi:[1,0,0]
    v_exp_f32 v44, v44
    v_exp_f32 v45, v45
    v_fma_mix_f32 v46, v129, s82, -v58 op_sel:[0,0,0] op_sel_hi:[1,0,0]
    v_fma_mix_f32 v47, v129, s82, -v58 op_sel:[1,0,0] op_sel_hi:[1,0,0]
    v_cvt_pk_bf16_f32 v128, v44, v45
    v_exp_f32 v46, v46
    v_exp_f32 v47, v47
    v_fma_mix_f32 v48, v130, s82, -v58 op_sel:[0,0,0] op_sel_hi:[1,0,0]
    v_fma_mix_f32 v49, v130, s82, -v58 op_sel:[1,0,0] op_sel_hi:[1,0,0]
    v_cvt_pk_bf16_f32 v129, v46, v47
    v_exp_f32 v48, v48
    v_exp_f32 v49, v49
    v_fma_mix_f32 v50, v131, s82, -v58 op_sel:[0,0,0] op_sel_hi:[1,0,0]
    v_fma_mix_f32 v51, v131, s82, -v58 op_sel:[1,0,0] op_sel_hi:[1,0,0]
    v_cvt_pk_bf16_f32 v130, v48, v49
    v_exp_f32 v50, v50
    v_exp_f32 v51, v51
    v_fma_mix_f32 v44, v132, s82, -v58 op_sel:[0,0,0] op_sel_hi:[1,0,0]
    v_fma_mix_f32 v45, v132, s82, -v58 op_sel:[1,0,0] op_sel_hi:[1,0,0]
    v_cvt_pk_bf16_f32 v131, v50, v51
    v_exp_f32 v44, v44
    v_exp_f32 v45, v45
    v_fma_mix_f32 v46, v133, s82, -v58 op_sel:[0,0,0] op_sel_hi:[1,0,0]
    v_fma_mix_f32 v47, v133, s82, -v58 op_sel:[1,0,0] op_sel_hi:[1,0,0]
    v_cvt_pk_bf16_f32 v132, v44, v45
    v_exp_f32 v46, v46
    v_exp_f32 v47, v47
    v_fma_mix_f32 v48, v134, s82, -v58 op_sel:[0,0,0] op_sel_hi:[1,0,0]
    v_fma_mix_f32 v49, v134, s82, -v58 op_sel:[1,0,0] op_sel_hi:[1,0,0]
    v_cvt_pk_bf16_f32 v133, v46, v47
    v_exp_f32 v48, v48
    v_exp_f32 v49, v49
    v_fma_mix_f32 v50, v135, s82, -v58 op_sel:[0,0,0] op_sel_hi:[1,0,0]
    v_fma_mix_f32 v51, v135, s82, -v58 op_sel:[1,0,0] op_sel_hi:[1,0,0]
    v_cvt_pk_bf16_f32 v134, v48, v49
    v_exp_f32 v50, v50
    v_exp_f32 v51, v51
    s_nop 0
    v_cvt_pk_bf16_f32 v135, v50, v51
    s_barrier
    ds_read_b64_tr_b16 a[0:1], v40 offset:0
    ds_read_b64_tr_b16 a[2:3], v40 offset:2048
    ds_read_b64_tr_b16 a[4:5], v41 offset:0
    ds_read_b64_tr_b16 a[6:7], v41 offset:2048
    ds_read_b64_tr_b16 a[8:9], v42 offset:0
    ds_read_b64_tr_b16 a[10:11], v42 offset:2048
    ds_read_b64_tr_b16 a[12:13], v43 offset:0
    ds_read_b64_tr_b16 a[14:15], v43 offset:2048
    ds_read_b64_tr_b16 a[16:17], v40 offset:4096
    ds_read_b64_tr_b16 a[18:19], v40 offset:6144
    ds_read_b64_tr_b16 a[20:21], v41 offset:4096
    ds_read_b64_tr_b16 a[22:23], v41 offset:6144
    ds_read_b64_tr_b16 a[24:25], v42 offset:4096
    ds_read_b64_tr_b16 a[26:27], v42 offset:6144
    ds_read_b64_tr_b16 a[28:29], v43 offset:4096
    s_waitcnt lgkmcnt(14)
    ds_read_b64_tr_b16 a[30:31], v43 offset:6144
    v_mfma_f32_32x32x16_bf16 a[72:87], a[88:91], v[128:131], 0
    s_waitcnt lgkmcnt(14)
    ds_read_b64_tr_b16 a[32:33], v40 offset:8192
    s_waitcnt lgkmcnt(14)
    ds_read_b64_tr_b16 a[34:35], v40 offset:10240
    v_fma_mix_f32 v44, v136, s82, -v58 op_sel:[0,0,0] op_sel_hi:[1,0,0]
    v_fma_mix_f32 v45, v136, s82, -v58 op_sel:[1,0,0] op_sel_hi:[1,0,0]
    v_exp_f32 v44, v44
    v_exp_f32 v45, v45
    v_mfma_f32_32x32x16_bf16 v[64:79], a[0:3], v[128:131], 0
    s_waitcnt lgkmcnt(14)
    ds_read_b64_tr_b16 a[36:37], v41 offset:8192
    s_waitcnt lgkmcnt(14)
    ds_read_b64_tr_b16 a[38:39], v41 offset:10240
    v_fma_mix_f32 v46, v137, s82, -v58 op_sel:[0,0,0] op_sel_hi:[1,0,0]
    v_fma_mix_f32 v47, v137, s82, -v58 op_sel:[1,0,0] op_sel_hi:[1,0,0]
    v_cvt_pk_bf16_f32 v136, v44, v45
    v_exp_f32 v46, v46
    v_mfma_f32_32x32x16_bf16 v[80:95], a[4:7], v[128:131], 0
    s_waitcnt lgkmcnt(14)
    ds_read_b64_tr_b16 a[40:41], v42 offset:8192
    s_waitcnt lgkmcnt(14)
    ds_read_b64_tr_b16 a[42:43], v42 offset:10240
    v_exp_f32 v47, v47
    v_fma_mix_f32 v48, v138, s82, -v58 op_sel:[0,0,0] op_sel_hi:[1,0,0]
    v_fma_mix_f32 v49, v138, s82, -v58 op_sel:[1,0,0] op_sel_hi:[1,0,0]
    v_cvt_pk_bf16_f32 v137, v46, v47
    v_mfma_f32_32x32x16_bf16 v[96:111], a[8:11], v[128:131], 0
    s_waitcnt lgkmcnt(14)
    ds_read_b64_tr_b16 a[44:45], v43 offset:8192
    s_waitcnt lgkmcnt(14)
    ds_read_b64_tr_b16 a[46:47], v43 offset:10240
    v_exp_f32 v48, v48
    v_exp_f32 v49, v49
    v_fma_mix_f32 v50, v139, s82, -v58 op_sel:[0,0,0] op_sel_hi:[1,0,0]
    v_fma_mix_f32 v51, v139, s82, -v58 op_sel:[1,0,0] op_sel_hi:[1,0,0]
    v_mfma_f32_32x32x16_bf16 v[112:127], a[12:15], v[128:131], 0
    s_waitcnt lgkmcnt(14)
    ds_read_b64_tr_b16 a[48:49], v40 offset:12288
    s_waitcnt lgkmcnt(14)
    ds_read_b64_tr_b16 a[50:51], v40 offset:14336
    v_cvt_pk_bf16_f32 v138, v48, v49
    v_exp_f32 v50, v50
    v_exp_f32 v51, v51
    v_fma_mix_f32 v44, v140, s82, -v58 op_sel:[0,0,0] op_sel_hi:[1,0,0]
    v_mfma_f32_32x32x16_bf16 a[72:87], a[88:91], v[132:135], a[72:87]
    s_waitcnt lgkmcnt(14)
    ds_read_b64_tr_b16 a[52:53], v41 offset:12288
    s_waitcnt lgkmcnt(14)
    ds_read_b64_tr_b16 a[54:55], v41 offset:14336
    v_fma_mix_f32 v45, v140, s82, -v58 op_sel:[1,0,0] op_sel_hi:[1,0,0]
    v_cvt_pk_bf16_f32 v139, v50, v51
    v_exp_f32 v44, v44
    v_exp_f32 v45, v45
    v_mfma_f32_32x32x16_bf16 v[64:79], a[16:19], v[132:135], v[64:79]
    s_waitcnt lgkmcnt(14)
    ds_read_b64_tr_b16 a[56:57], v42 offset:12288
    s_waitcnt lgkmcnt(14)
    ds_read_b64_tr_b16 a[58:59], v42 offset:14336
    v_fma_mix_f32 v46, v141, s82, -v58 op_sel:[0,0,0] op_sel_hi:[1,0,0]
    v_fma_mix_f32 v47, v141, s82, -v58 op_sel:[1,0,0] op_sel_hi:[1,0,0]
    v_cvt_pk_bf16_f32 v140, v44, v45
    v_exp_f32 v46, v46
    v_mfma_f32_32x32x16_bf16 v[80:95], a[20:23], v[132:135], v[80:95]
    s_waitcnt lgkmcnt(14)
    ds_read_b64_tr_b16 a[60:61], v43 offset:12288
    s_waitcnt lgkmcnt(14)
    ds_read_b64_tr_b16 a[62:63], v43 offset:14336
    v_exp_f32 v47, v47
    v_fma_mix_f32 v48, v142, s82, -v58 op_sel:[0,0,0] op_sel_hi:[1,0,0]
    v_fma_mix_f32 v49, v142, s82, -v58 op_sel:[1,0,0] op_sel_hi:[1,0,0]
    v_cvt_pk_bf16_f32 v141, v46, v47
    v_mfma_f32_32x32x16_bf16 v[96:111], a[24:27], v[132:135], v[96:111]
    v_exp_f32 v48, v48
    v_exp_f32 v49, v49
    v_fma_mix_f32 v50, v143, s82, -v58 op_sel:[0,0,0] op_sel_hi:[1,0,0]
    v_fma_mix_f32 v51, v143, s82, -v58 op_sel:[1,0,0] op_sel_hi:[1,0,0]
    v_mfma_f32_32x32x16_bf16 v[112:127], a[28:31], v[132:135], v[112:127]
    v_cvt_pk_bf16_f32 v142, v48, v49
    v_exp_f32 v50, v50
    v_exp_f32 v51, v51
    s_nop 0
    v_cvt_pk_bf16_f32 v143, v50, v51
    v_mfma_f32_32x32x16_bf16 a[72:87], a[88:91], v[136:139], a[72:87]
    v_fma_mix_f32 v44, v144, s82, -v58 op_sel:[0,0,0] op_sel_hi:[1,0,0]
    v_fma_mix_f32 v45, v144, s82, -v58 op_sel:[1,0,0] op_sel_hi:[1,0,0]
    v_exp_f32 v44, v44
    v_exp_f32 v45, v45
    v_fma_mix_f32 v46, v145, s82, -v58 op_sel:[0,0,0] op_sel_hi:[1,0,0]
    s_waitcnt lgkmcnt(14)
    v_mfma_f32_32x32x16_bf16 v[64:79], a[32:35], v[136:139], v[64:79]
    v_fma_mix_f32 v47, v145, s82, -v58 op_sel:[1,0,0] op_sel_hi:[1,0,0]
    v_cvt_pk_bf16_f32 v144, v44, v45
    v_exp_f32 v46, v46
    v_exp_f32 v47, v47
    v_fma_mix_f32 v48, v146, s82, -v58 op_sel:[0,0,0] op_sel_hi:[1,0,0]
    s_waitcnt lgkmcnt(12)
    v_mfma_f32_32x32x16_bf16 v[80:95], a[36:39], v[136:139], v[80:95]
    v_fma_mix_f32 v49, v146, s82, -v58 op_sel:[1,0,0] op_sel_hi:[1,0,0]
    v_cvt_pk_bf16_f32 v145, v46, v47
    v_exp_f32 v48, v48
    v_exp_f32 v49, v49
    v_fma_mix_f32 v50, v147, s82, -v58 op_sel:[0,0,0] op_sel_hi:[1,0,0]
    s_waitcnt lgkmcnt(10)
    v_mfma_f32_32x32x16_bf16 v[96:111], a[40:43], v[136:139], v[96:111]
    v_fma_mix_f32 v51, v147, s82, -v58 op_sel:[1,0,0] op_sel_hi:[1,0,0]
    v_cvt_pk_bf16_f32 v146, v48, v49
    v_exp_f32 v50, v50
    v_exp_f32 v51, v51
    v_fma_mix_f32 v44, v148, s82, -v58 op_sel:[0,0,0] op_sel_hi:[1,0,0]
    s_waitcnt lgkmcnt(8)
    v_mfma_f32_32x32x16_bf16 v[112:127], a[44:47], v[136:139], v[112:127]
    v_fma_mix_f32 v45, v148, s82, -v58 op_sel:[1,0,0] op_sel_hi:[1,0,0]
    v_cvt_pk_bf16_f32 v147, v50, v51
    v_exp_f32 v44, v44
    v_exp_f32 v45, v45
    v_fma_mix_f32 v46, v149, s82, -v58 op_sel:[0,0,0] op_sel_hi:[1,0,0]
    v_mfma_f32_32x32x16_bf16 a[72:87], a[88:91], v[140:143], a[72:87]
    v_fma_mix_f32 v47, v149, s82, -v58 op_sel:[1,0,0] op_sel_hi:[1,0,0]
    v_cvt_pk_bf16_f32 v148, v44, v45
    v_exp_f32 v46, v46
    v_exp_f32 v47, v47
    v_fma_mix_f32 v48, v150, s82, -v58 op_sel:[0,0,0] op_sel_hi:[1,0,0]
    s_waitcnt lgkmcnt(6)
    v_mfma_f32_32x32x16_bf16 v[64:79], a[48:51], v[140:143], v[64:79]
    v_fma_mix_f32 v49, v150, s82, -v58 op_sel:[1,0,0] op_sel_hi:[1,0,0]
    v_cvt_pk_bf16_f32 v149, v46, v47
    v_exp_f32 v48, v48
    v_exp_f32 v49, v49
    v_fma_mix_f32 v50, v151, s82, -v58 op_sel:[0,0,0] op_sel_hi:[1,0,0]
    s_barrier
    ds_read_b64_tr_b16 a[0:1], v40 offset:16384
    ds_read_b64_tr_b16 a[2:3], v40 offset:18432
    ds_read_b64_tr_b16 a[4:5], v41 offset:16384
    ds_read_b64_tr_b16 a[6:7], v41 offset:18432
    s_waitcnt lgkmcnt(8)
    v_mfma_f32_32x32x16_bf16 v[80:95], a[52:55], v[140:143], v[80:95]
    ds_read_b64_tr_b16 a[8:9], v42 offset:16384
    ds_read_b64_tr_b16 a[10:11], v42 offset:18432
    ds_read_b64_tr_b16 a[12:13], v43 offset:16384
    ds_read_b64_tr_b16 a[14:15], v43 offset:18432
    v_fma_mix_f32 v51, v151, s82, -v58 op_sel:[1,0,0] op_sel_hi:[1,0,0]
    v_cvt_pk_bf16_f32 v150, v48, v49
    s_waitcnt lgkmcnt(10)
    v_mfma_f32_32x32x16_bf16 v[96:111], a[56:59], v[140:143], v[96:111]
    ds_read_b64_tr_b16 a[16:17], v40 offset:20480
    ds_read_b64_tr_b16 a[18:19], v40 offset:22528
    ds_read_b64_tr_b16 a[20:21], v41 offset:20480
    ds_read_b64_tr_b16 a[22:23], v41 offset:22528
    v_exp_f32 v50, v50
    v_exp_f32 v51, v51
    s_waitcnt lgkmcnt(12)
    v_mfma_f32_32x32x16_bf16 v[112:127], a[60:63], v[140:143], v[112:127]
    ds_read_b64_tr_b16 a[24:25], v42 offset:20480
    ds_read_b64_tr_b16 a[26:27], v42 offset:22528
    ds_read_b64_tr_b16 a[28:29], v43 offset:20480
    s_waitcnt lgkmcnt(14)
    ds_read_b64_tr_b16 a[30:31], v43 offset:22528
    v_cvt_pk_bf16_f32 v151, v50, v51
    v_mfma_f32_32x32x16_bf16 a[72:87], a[88:91], v[144:147], a[72:87]
    s_waitcnt lgkmcnt(14)
    ds_read_b64_tr_b16 a[32:33], v40 offset:24576
    s_waitcnt lgkmcnt(14)
    ds_read_b64_tr_b16 a[34:35], v40 offset:26624
    v_fma_mix_f32 v44, v152, s82, -v58 op_sel:[0,0,0] op_sel_hi:[1,0,0]
    v_fma_mix_f32 v45, v152, s82, -v58 op_sel:[1,0,0] op_sel_hi:[1,0,0]
    v_exp_f32 v44, v44
    v_exp_f32 v45, v45
    v_mfma_f32_32x32x16_bf16 v[64:79], a[0:3], v[144:147], v[64:79]
    s_waitcnt lgkmcnt(14)
    ds_read_b64_tr_b16 a[36:37], v41 offset:24576
    s_waitcnt lgkmcnt(14)
    ds_read_b64_tr_b16 a[38:39], v41 offset:26624
    v_fma_mix_f32 v46, v153, s82, -v58 op_sel:[0,0,0] op_sel_hi:[1,0,0]
    v_fma_mix_f32 v47, v153, s82, -v58 op_sel:[1,0,0] op_sel_hi:[1,0,0]
    v_cvt_pk_bf16_f32 v152, v44, v45
    v_exp_f32 v46, v46
    v_mfma_f32_32x32x16_bf16 v[80:95], a[4:7], v[144:147], v[80:95]
    s_waitcnt lgkmcnt(14)
    ds_read_b64_tr_b16 a[40:41], v42 offset:24576
    s_waitcnt lgkmcnt(14)
    ds_read_b64_tr_b16 a[42:43], v42 offset:26624
    v_exp_f32 v47, v47
    v_fma_mix_f32 v48, v154, s82, -v58 op_sel:[0,0,0] op_sel_hi:[1,0,0]
    v_fma_mix_f32 v49, v154, s82, -v58 op_sel:[1,0,0] op_sel_hi:[1,0,0]
    v_cvt_pk_bf16_f32 v153, v46, v47
    v_mfma_f32_32x32x16_bf16 v[96:111], a[8:11], v[144:147], v[96:111]
    s_waitcnt lgkmcnt(14)
    ds_read_b64_tr_b16 a[44:45], v43 offset:24576
    s_waitcnt lgkmcnt(14)
    ds_read_b64_tr_b16 a[46:47], v43 offset:26624
    v_exp_f32 v48, v48
    v_exp_f32 v49, v49
    v_fma_mix_f32 v50, v155, s82, -v58 op_sel:[0,0,0] op_sel_hi:[1,0,0]
    v_fma_mix_f32 v51, v155, s82, -v58 op_sel:[1,0,0] op_sel_hi:[1,0,0]
    v_mfma_f32_32x32x16_bf16 v[112:127], a[12:15], v[144:147], v[112:127]
    s_waitcnt lgkmcnt(14)
    ds_read_b64_tr_b16 a[48:49], v40 offset:28672
    s_waitcnt lgkmcnt(14)
    ds_read_b64_tr_b16 a[50:51], v40 offset:30720
    v_cvt_pk_bf16_f32 v154, v48, v49
    v_exp_f32 v50, v50
    v_exp_f32 v51, v51
    v_fma_mix_f32 v44, v156, s82, -v58 op_sel:[0,0,0] op_sel_hi:[1,0,0]
    v_mfma_f32_32x32x16_bf16 a[72:87], a[88:91], v[148:151], a[72:87]
    s_waitcnt lgkmcnt(14)
    ds_read_b64_tr_b16 a[52:53], v41 offset:28672
    s_waitcnt lgkmcnt(14)
    ds_read_b64_tr_b16 a[54:55], v41 offset:30720
    v_fma_mix_f32 v45, v156, s82, -v58 op_sel:[1,0,0] op_sel_hi:[1,0,0]
    v_cvt_pk_bf16_f32 v155, v50, v51
    v_exp_f32 v44, v44
    v_exp_f32 v45, v45
    v_mfma_f32_32x32x16_bf16 v[64:79], a[16:19], v[148:151], v[64:79]
    s_waitcnt lgkmcnt(14)
    ds_read_b64_tr_b16 a[56:57], v42 offset:28672
    s_waitcnt lgkmcnt(14)
    ds_read_b64_tr_b16 a[58:59], v42 offset:30720
    v_fma_mix_f32 v46, v157, s82, -v58 op_sel:[0,0,0] op_sel_hi:[1,0,0]
    v_fma_mix_f32 v47, v157, s82, -v58 op_sel:[1,0,0] op_sel_hi:[1,0,0]
    v_cvt_pk_bf16_f32 v156, v44, v45
    v_exp_f32 v46, v46
    v_mfma_f32_32x32x16_bf16 v[80:95], a[20:23], v[148:151], v[80:95]
    s_waitcnt lgkmcnt(14)
    ds_read_b64_tr_b16 a[60:61], v43 offset:28672
    s_waitcnt lgkmcnt(14)
    ds_read_b64_tr_b16 a[62:63], v43 offset:30720
    v_exp_f32 v47, v47
    v_fma_mix_f32 v48, v158, s82, -v58 op_sel:[0,0,0] op_sel_hi:[1,0,0]
    v_fma_mix_f32 v49, v158, s82, -v58 op_sel:[1,0,0] op_sel_hi:[1,0,0]
    v_cvt_pk_bf16_f32 v157, v46, v47
    v_mfma_f32_32x32x16_bf16 v[96:111], a[24:27], v[148:151], v[96:111]
    v_exp_f32 v48, v48
    v_exp_f32 v49, v49
    v_fma_mix_f32 v50, v159, s82, -v58 op_sel:[0,0,0] op_sel_hi:[1,0,0]
    v_fma_mix_f32 v51, v159, s82, -v58 op_sel:[1,0,0] op_sel_hi:[1,0,0]
    v_mfma_f32_32x32x16_bf16 v[112:127], a[28:31], v[148:151], v[112:127]
    v_cvt_pk_bf16_f32 v158, v48, v49
    v_exp_f32 v50, v50
    v_exp_f32 v51, v51
    s_nop 0
    v_cvt_pk_bf16_f32 v159, v50, v51
    v_mfma_f32_32x32x16_bf16 a[72:87], a[88:91], v[152:155], a[72:87]
    v_fma_mix_f32 v44, v160, s82, -v58 op_sel:[0,0,0] op_sel_hi:[1,0,0]
    v_fma_mix_f32 v45, v160, s82, -v58 op_sel:[1,0,0] op_sel_hi:[1,0,0]
    v_exp_f32 v44, v44
    v_exp_f32 v45, v45
    v_fma_mix_f32 v46, v161, s82, -v58 op_sel:[0,0,0] op_sel_hi:[1,0,0]
    s_waitcnt lgkmcnt(14)
    v_mfma_f32_32x32x16_bf16 v[64:79], a[32:35], v[152:155], v[64:79]
    v_fma_mix_f32 v47, v161, s82, -v58 op_sel:[1,0,0] op_sel_hi:[1,0,0]
    v_cvt_pk_bf16_f32 v160, v44, v45
    v_exp_f32 v46, v46
    v_exp_f32 v47, v47
    v_fma_mix_f32 v48, v162, s82, -v58 op_sel:[0,0,0] op_sel_hi:[1,0,0]
    s_waitcnt lgkmcnt(12)
    v_mfma_f32_32x32x16_bf16 v[80:95], a[36:39], v[152:155], v[80:95]
    v_fma_mix_f32 v49, v162, s82, -v58 op_sel:[1,0,0] op_sel_hi:[1,0,0]
    v_cvt_pk_bf16_f32 v161, v46, v47
    v_exp_f32 v48, v48
    v_exp_f32 v49, v49
    v_fma_mix_f32 v50, v163, s82, -v58 op_sel:[0,0,0] op_sel_hi:[1,0,0]
    s_waitcnt lgkmcnt(10)
    v_mfma_f32_32x32x16_bf16 v[96:111], a[40:43], v[152:155], v[96:111]
    v_fma_mix_f32 v51, v163, s82, -v58 op_sel:[1,0,0] op_sel_hi:[1,0,0]
    v_cvt_pk_bf16_f32 v162, v48, v49
    v_exp_f32 v50, v50
    v_exp_f32 v51, v51
    v_fma_mix_f32 v44, v164, s82, -v58 op_sel:[0,0,0] op_sel_hi:[1,0,0]
    s_waitcnt lgkmcnt(8)
    v_mfma_f32_32x32x16_bf16 v[112:127], a[44:47], v[152:155], v[112:127]
    v_fma_mix_f32 v45, v164, s82, -v58 op_sel:[1,0,0] op_sel_hi:[1,0,0]
    v_cvt_pk_bf16_f32 v163, v50, v51
    v_exp_f32 v44, v44
    v_exp_f32 v45, v45
    v_fma_mix_f32 v46, v165, s82, -v58 op_sel:[0,0,0] op_sel_hi:[1,0,0]
    v_mfma_f32_32x32x16_bf16 a[72:87], a[88:91], v[156:159], a[72:87]
    v_fma_mix_f32 v47, v165, s82, -v58 op_sel:[1,0,0] op_sel_hi:[1,0,0]
    v_cvt_pk_bf16_f32 v164, v44, v45
    v_exp_f32 v46, v46
    v_exp_f32 v47, v47
    v_fma_mix_f32 v48, v166, s82, -v58 op_sel:[0,0,0] op_sel_hi:[1,0,0]
    s_waitcnt lgkmcnt(6)
    v_mfma_f32_32x32x16_bf16 v[64:79], a[48:51], v[156:159], v[64:79]
    v_fma_mix_f32 v49, v166, s82, -v58 op_sel:[1,0,0] op_sel_hi:[1,0,0]
    v_cvt_pk_bf16_f32 v165, v46, v47
    v_exp_f32 v48, v48
    v_exp_f32 v49, v49
    v_fma_mix_f32 v50, v167, s82, -v58 op_sel:[0,0,0] op_sel_hi:[1,0,0]
    s_barrier
    ds_read_b64_tr_b16 a[0:1], v32 offset:0
    ds_read_b64_tr_b16 a[2:3], v32 offset:2048
    ds_read_b64_tr_b16 a[4:5], v33 offset:0
    ds_read_b64_tr_b16 a[6:7], v33 offset:2048
    s_waitcnt lgkmcnt(8)
    v_mfma_f32_32x32x16_bf16 v[80:95], a[52:55], v[156:159], v[80:95]
    ds_read_b64_tr_b16 a[8:9], v34 offset:0
    ds_read_b64_tr_b16 a[10:11], v34 offset:2048
    ds_read_b64_tr_b16 a[12:13], v35 offset:0
    ds_read_b64_tr_b16 a[14:15], v35 offset:2048
    v_fma_mix_f32 v51, v167, s82, -v58 op_sel:[1,0,0] op_sel_hi:[1,0,0]
    v_cvt_pk_bf16_f32 v166, v48, v49
    s_waitcnt lgkmcnt(10)
    v_mfma_f32_32x32x16_bf16 v[96:111], a[56:59], v[156:159], v[96:111]
    ds_read_b64_tr_b16 a[16:17], v32 offset:4096
    ds_read_b64_tr_b16 a[18:19], v32 offset:6144
    ds_read_b64_tr_b16 a[20:21], v33 offset:4096
    ds_read_b64_tr_b16 a[22:23], v33 offset:6144
    v_exp_f32 v50, v50
    v_exp_f32 v51, v51
    s_waitcnt lgkmcnt(12)
    v_mfma_f32_32x32x16_bf16 v[112:127], a[60:63], v[156:159], v[112:127]
    ds_read_b64_tr_b16 a[24:25], v34 offset:4096
    ds_read_b64_tr_b16 a[26:27], v34 offset:6144
    ds_read_b64_tr_b16 a[28:29], v35 offset:4096
    s_waitcnt lgkmcnt(14)
    ds_read_b64_tr_b16 a[30:31], v35 offset:6144
    v_cvt_pk_bf16_f32 v167, v50, v51
    v_mfma_f32_32x32x16_bf16 a[72:87], a[88:91], v[160:163], a[72:87]
    s_waitcnt lgkmcnt(14)
    ds_read_b64_tr_b16 a[32:33], v32 offset:8192
    s_waitcnt lgkmcnt(14)
    ds_read_b64_tr_b16 a[34:35], v32 offset:10240
    v_fma_mix_f32 v44, v168, s82, -v58 op_sel:[0,0,0] op_sel_hi:[1,0,0]
    v_fma_mix_f32 v45, v168, s82, -v58 op_sel:[1,0,0] op_sel_hi:[1,0,0]
    v_exp_f32 v44, v44
    v_exp_f32 v45, v45
    v_mfma_f32_32x32x16_bf16 v[64:79], a[0:3], v[160:163], v[64:79]
    s_waitcnt lgkmcnt(14)
    ds_read_b64_tr_b16 a[36:37], v33 offset:8192
    s_waitcnt lgkmcnt(14)
    ds_read_b64_tr_b16 a[38:39], v33 offset:10240
    v_fma_mix_f32 v46, v169, s82, -v58 op_sel:[0,0,0] op_sel_hi:[1,0,0]
    v_fma_mix_f32 v47, v169, s82, -v58 op_sel:[1,0,0] op_sel_hi:[1,0,0]
    v_cvt_pk_bf16_f32 v168, v44, v45
    v_exp_f32 v46, v46
    v_mfma_f32_32x32x16_bf16 v[80:95], a[4:7], v[160:163], v[80:95]
    s_waitcnt lgkmcnt(14)
    ds_read_b64_tr_b16 a[40:41], v34 offset:8192
    s_waitcnt lgkmcnt(14)
    ds_read_b64_tr_b16 a[42:43], v34 offset:10240
    v_exp_f32 v47, v47
    v_fma_mix_f32 v48, v170, s82, -v58 op_sel:[0,0,0] op_sel_hi:[1,0,0]
    v_fma_mix_f32 v49, v170, s82, -v58 op_sel:[1,0,0] op_sel_hi:[1,0,0]
    v_cvt_pk_bf16_f32 v169, v46, v47
    v_mfma_f32_32x32x16_bf16 v[96:111], a[8:11], v[160:163], v[96:111]
    s_waitcnt lgkmcnt(14)
    ds_read_b64_tr_b16 a[44:45], v35 offset:8192
    s_waitcnt lgkmcnt(14)
    ds_read_b64_tr_b16 a[46:47], v35 offset:10240
    v_exp_f32 v48, v48
    v_exp_f32 v49, v49
    v_fma_mix_f32 v50, v171, s82, -v58 op_sel:[0,0,0] op_sel_hi:[1,0,0]
    v_fma_mix_f32 v51, v171, s82, -v58 op_sel:[1,0,0] op_sel_hi:[1,0,0]
    v_mfma_f32_32x32x16_bf16 v[112:127], a[12:15], v[160:163], v[112:127]
    s_waitcnt lgkmcnt(14)
    ds_read_b64_tr_b16 a[48:49], v32 offset:12288
    s_waitcnt lgkmcnt(14)
    ds_read_b64_tr_b16 a[50:51], v32 offset:14336
    v_cvt_pk_bf16_f32 v170, v48, v49
    v_exp_f32 v50, v50
    v_exp_f32 v51, v51
    v_fma_mix_f32 v44, v172, s82, -v58 op_sel:[0,0,0] op_sel_hi:[1,0,0]
    v_mfma_f32_32x32x16_bf16 a[72:87], a[88:91], v[164:167], a[72:87]
    s_waitcnt lgkmcnt(14)
    ds_read_b64_tr_b16 a[52:53], v33 offset:12288
    s_waitcnt lgkmcnt(14)
    ds_read_b64_tr_b16 a[54:55], v33 offset:14336
    v_fma_mix_f32 v45, v172, s82, -v58 op_sel:[1,0,0] op_sel_hi:[1,0,0]
    v_cvt_pk_bf16_f32 v171, v50, v51
    v_exp_f32 v44, v44
    v_exp_f32 v45, v45
    v_mfma_f32_32x32x16_bf16 v[64:79], a[16:19], v[164:167], v[64:79]
    s_waitcnt lgkmcnt(14)
    ds_read_b64_tr_b16 a[56:57], v34 offset:12288
    s_waitcnt lgkmcnt(14)
    ds_read_b64_tr_b16 a[58:59], v34 offset:14336
    v_fma_mix_f32 v46, v173, s82, -v58 op_sel:[0,0,0] op_sel_hi:[1,0,0]
    v_fma_mix_f32 v47, v173, s82, -v58 op_sel:[1,0,0] op_sel_hi:[1,0,0]
    v_cvt_pk_bf16_f32 v172, v44, v45
    v_exp_f32 v46, v46
    v_mfma_f32_32x32x16_bf16 v[80:95], a[20:23], v[164:167], v[80:95]
    s_waitcnt lgkmcnt(14)
    ds_read_b64_tr_b16 a[60:61], v35 offset:12288
    s_waitcnt lgkmcnt(14)
    ds_read_b64_tr_b16 a[62:63], v35 offset:14336
    v_exp_f32 v47, v47
    v_fma_mix_f32 v48, v174, s82, -v58 op_sel:[0,0,0] op_sel_hi:[1,0,0]
    v_fma_mix_f32 v49, v174, s82, -v58 op_sel:[1,0,0] op_sel_hi:[1,0,0]
    v_cvt_pk_bf16_f32 v173, v46, v47
    v_mfma_f32_32x32x16_bf16 v[96:111], a[24:27], v[164:167], v[96:111]
    v_exp_f32 v48, v48
    v_exp_f32 v49, v49
    v_fma_mix_f32 v50, v175, s82, -v58 op_sel:[0,0,0] op_sel_hi:[1,0,0]
    v_fma_mix_f32 v51, v175, s82, -v58 op_sel:[1,0,0] op_sel_hi:[1,0,0]
    v_mfma_f32_32x32x16_bf16 v[112:127], a[28:31], v[164:167], v[112:127]
    v_cvt_pk_bf16_f32 v174, v48, v49
    v_exp_f32 v50, v50
    v_exp_f32 v51, v51
    s_nop 0
    v_cvt_pk_bf16_f32 v175, v50, v51
    v_mfma_f32_32x32x16_bf16 a[72:87], a[88:91], v[168:171], a[72:87]
    v_fma_mix_f32 v44, v176, s82, -v58 op_sel:[0,0,0] op_sel_hi:[1,0,0]
    v_fma_mix_f32 v45, v176, s82, -v58 op_sel:[1,0,0] op_sel_hi:[1,0,0]
    v_exp_f32 v44, v44
    v_exp_f32 v45, v45
    v_fma_mix_f32 v46, v177, s82, -v58 op_sel:[0,0,0] op_sel_hi:[1,0,0]
    s_waitcnt lgkmcnt(14)
    v_mfma_f32_32x32x16_bf16 v[64:79], a[32:35], v[168:171], v[64:79]
    v_fma_mix_f32 v47, v177, s82, -v58 op_sel:[1,0,0] op_sel_hi:[1,0,0]
    v_cvt_pk_bf16_f32 v176, v44, v45
    v_exp_f32 v46, v46
    v_exp_f32 v47, v47
    v_fma_mix_f32 v48, v178, s82, -v58 op_sel:[0,0,0] op_sel_hi:[1,0,0]
    s_waitcnt lgkmcnt(12)
    v_mfma_f32_32x32x16_bf16 v[80:95], a[36:39], v[168:171], v[80:95]
    v_fma_mix_f32 v49, v178, s82, -v58 op_sel:[1,0,0] op_sel_hi:[1,0,0]
    v_cvt_pk_bf16_f32 v177, v46, v47
    v_exp_f32 v48, v48
    v_exp_f32 v49, v49
    v_fma_mix_f32 v50, v179, s82, -v58 op_sel:[0,0,0] op_sel_hi:[1,0,0]
    s_waitcnt lgkmcnt(10)
    v_mfma_f32_32x32x16_bf16 v[96:111], a[40:43], v[168:171], v[96:111]
    v_fma_mix_f32 v51, v179, s82, -v58 op_sel:[1,0,0] op_sel_hi:[1,0,0]
    v_cvt_pk_bf16_f32 v178, v48, v49
    v_exp_f32 v50, v50
    v_exp_f32 v51, v51
    v_fma_mix_f32 v44, v180, s82, -v58 op_sel:[0,0,0] op_sel_hi:[1,0,0]
    s_waitcnt lgkmcnt(8)
    v_mfma_f32_32x32x16_bf16 v[112:127], a[44:47], v[168:171], v[112:127]
    v_fma_mix_f32 v45, v180, s82, -v58 op_sel:[1,0,0] op_sel_hi:[1,0,0]
    v_cvt_pk_bf16_f32 v179, v50, v51
    v_exp_f32 v44, v44
    v_exp_f32 v45, v45
    v_fma_mix_f32 v46, v181, s82, -v58 op_sel:[0,0,0] op_sel_hi:[1,0,0]
    v_mfma_f32_32x32x16_bf16 a[72:87], a[88:91], v[172:175], a[72:87]
    v_fma_mix_f32 v47, v181, s82, -v58 op_sel:[1,0,0] op_sel_hi:[1,0,0]
    v_cvt_pk_bf16_f32 v180, v44, v45
    v_exp_f32 v46, v46
    v_exp_f32 v47, v47
    v_fma_mix_f32 v48, v182, s82, -v58 op_sel:[0,0,0] op_sel_hi:[1,0,0]
    s_waitcnt lgkmcnt(6)
    v_mfma_f32_32x32x16_bf16 v[64:79], a[48:51], v[172:175], v[64:79]
    v_fma_mix_f32 v49, v182, s82, -v58 op_sel:[1,0,0] op_sel_hi:[1,0,0]
    v_cvt_pk_bf16_f32 v181, v46, v47
    v_exp_f32 v48, v48
    v_exp_f32 v49, v49
    v_fma_mix_f32 v50, v183, s82, -v58 op_sel:[0,0,0] op_sel_hi:[1,0,0]
    s_barrier
    ds_read_b64_tr_b16 a[0:1], v32 offset:16384
    ds_read_b64_tr_b16 a[2:3], v32 offset:18432
    ds_read_b64_tr_b16 a[4:5], v33 offset:16384
    ds_read_b64_tr_b16 a[6:7], v33 offset:18432
    s_waitcnt lgkmcnt(8)
    v_mfma_f32_32x32x16_bf16 v[80:95], a[52:55], v[172:175], v[80:95]
    ds_read_b64_tr_b16 a[8:9], v34 offset:16384
    ds_read_b64_tr_b16 a[10:11], v34 offset:18432
    ds_read_b64_tr_b16 a[12:13], v35 offset:16384
    ds_read_b64_tr_b16 a[14:15], v35 offset:18432
    v_fma_mix_f32 v51, v183, s82, -v58 op_sel:[1,0,0] op_sel_hi:[1,0,0]
    v_cvt_pk_bf16_f32 v182, v48, v49
    s_waitcnt lgkmcnt(10)
    v_mfma_f32_32x32x16_bf16 v[96:111], a[56:59], v[172:175], v[96:111]
    ds_read_b64_tr_b16 a[16:17], v32 offset:20480
    ds_read_b64_tr_b16 a[18:19], v32 offset:22528
    ds_read_b64_tr_b16 a[20:21], v33 offset:20480
    ds_read_b64_tr_b16 a[22:23], v33 offset:22528
    v_exp_f32 v50, v50
    v_exp_f32 v51, v51
    s_waitcnt lgkmcnt(12)
    v_mfma_f32_32x32x16_bf16 v[112:127], a[60:63], v[172:175], v[112:127]
    ds_read_b64_tr_b16 a[24:25], v34 offset:20480
    ds_read_b64_tr_b16 a[26:27], v34 offset:22528
    ds_read_b64_tr_b16 a[28:29], v35 offset:20480
    s_waitcnt lgkmcnt(14)
    ds_read_b64_tr_b16 a[30:31], v35 offset:22528
    v_cvt_pk_bf16_f32 v183, v50, v51
    v_mfma_f32_32x32x16_bf16 a[72:87], a[88:91], v[176:179], a[72:87]
    s_waitcnt lgkmcnt(14)
    ds_read_b64_tr_b16 a[32:33], v32 offset:24576
    s_waitcnt lgkmcnt(14)
    ds_read_b64_tr_b16 a[34:35], v32 offset:26624
    v_fma_mix_f32 v44, v184, s82, -v58 op_sel:[0,0,0] op_sel_hi:[1,0,0]
    v_fma_mix_f32 v45, v184, s82, -v58 op_sel:[1,0,0] op_sel_hi:[1,0,0]
    v_exp_f32 v44, v44
    v_exp_f32 v45, v45
    v_mfma_f32_32x32x16_bf16 v[64:79], a[0:3], v[176:179], v[64:79]
    s_waitcnt lgkmcnt(14)
    ds_read_b64_tr_b16 a[36:37], v33 offset:24576
    s_waitcnt lgkmcnt(14)
    ds_read_b64_tr_b16 a[38:39], v33 offset:26624
    v_fma_mix_f32 v46, v185, s82, -v58 op_sel:[0,0,0] op_sel_hi:[1,0,0]
    v_fma_mix_f32 v47, v185, s82, -v58 op_sel:[1,0,0] op_sel_hi:[1,0,0]
    v_cvt_pk_bf16_f32 v184, v44, v45
    v_exp_f32 v46, v46
    v_mfma_f32_32x32x16_bf16 v[80:95], a[4:7], v[176:179], v[80:95]
    s_waitcnt lgkmcnt(14)
    ds_read_b64_tr_b16 a[40:41], v34 offset:24576
    s_waitcnt lgkmcnt(14)
    ds_read_b64_tr_b16 a[42:43], v34 offset:26624
    v_exp_f32 v47, v47
    v_fma_mix_f32 v48, v186, s82, -v58 op_sel:[0,0,0] op_sel_hi:[1,0,0]
    v_fma_mix_f32 v49, v186, s82, -v58 op_sel:[1,0,0] op_sel_hi:[1,0,0]
    v_cvt_pk_bf16_f32 v185, v46, v47
    v_mfma_f32_32x32x16_bf16 v[96:111], a[8:11], v[176:179], v[96:111]
    s_waitcnt lgkmcnt(14)
    ds_read_b64_tr_b16 a[44:45], v35 offset:24576
    s_waitcnt lgkmcnt(14)
    ds_read_b64_tr_b16 a[46:47], v35 offset:26624
    v_exp_f32 v48, v48
    v_exp_f32 v49, v49
    v_fma_mix_f32 v50, v187, s82, -v58 op_sel:[0,0,0] op_sel_hi:[1,0,0]
    v_fma_mix_f32 v51, v187, s82, -v58 op_sel:[1,0,0] op_sel_hi:[1,0,0]
    v_mfma_f32_32x32x16_bf16 v[112:127], a[12:15], v[176:179], v[112:127]
    s_waitcnt lgkmcnt(14)
    ds_read_b64_tr_b16 a[48:49], v32 offset:28672
    s_waitcnt lgkmcnt(14)
    ds_read_b64_tr_b16 a[50:51], v32 offset:30720
    v_cvt_pk_bf16_f32 v186, v48, v49
    v_exp_f32 v50, v50
    v_exp_f32 v51, v51
    v_fma_mix_f32 v44, v188, s82, -v58 op_sel:[0,0,0] op_sel_hi:[1,0,0]
    v_mfma_f32_32x32x16_bf16 a[72:87], a[88:91], v[180:183], a[72:87]
    s_waitcnt lgkmcnt(14)
    ds_read_b64_tr_b16 a[52:53], v33 offset:28672
    s_waitcnt lgkmcnt(14)
    ds_read_b64_tr_b16 a[54:55], v33 offset:30720
    v_fma_mix_f32 v45, v188, s82, -v58 op_sel:[1,0,0] op_sel_hi:[1,0,0]
    v_cvt_pk_bf16_f32 v187, v50, v51
    v_exp_f32 v44, v44
    v_exp_f32 v45, v45
    v_mfma_f32_32x32x16_bf16 v[64:79], a[16:19], v[180:183], v[64:79]
    s_waitcnt lgkmcnt(14)
    ds_read_b64_tr_b16 a[56:57], v34 offset:28672
    s_waitcnt lgkmcnt(14)
    ds_read_b64_tr_b16 a[58:59], v34 offset:30720
    v_fma_mix_f32 v46, v189, s82, -v58 op_sel:[0,0,0] op_sel_hi:[1,0,0]
    v_fma_mix_f32 v47, v189, s82, -v58 op_sel:[1,0,0] op_sel_hi:[1,0,0]
    v_cvt_pk_bf16_f32 v188, v44, v45
    v_exp_f32 v46, v46
    v_mfma_f32_32x32x16_bf16 v[80:95], a[20:23], v[180:183], v[80:95]
    s_waitcnt lgkmcnt(14)
    ds_read_b64_tr_b16 a[60:61], v35 offset:28672
    s_waitcnt lgkmcnt(14)
    ds_read_b64_tr_b16 a[62:63], v35 offset:30720
    v_exp_f32 v47, v47
    v_fma_mix_f32 v48, v190, s82, -v58 op_sel:[0,0,0] op_sel_hi:[1,0,0]
    v_fma_mix_f32 v49, v190, s82, -v58 op_sel:[1,0,0] op_sel_hi:[1,0,0]
    v_cvt_pk_bf16_f32 v189, v46, v47
    v_mfma_f32_32x32x16_bf16 v[96:111], a[24:27], v[180:183], v[96:111]
    v_exp_f32 v48, v48
    v_exp_f32 v49, v49
    v_fma_mix_f32 v50, v191, s82, -v58 op_sel:[0,0,0] op_sel_hi:[1,0,0]
    v_fma_mix_f32 v51, v191, s82, -v58 op_sel:[1,0,0] op_sel_hi:[1,0,0]
    v_mfma_f32_32x32x16_bf16 v[112:127], a[28:31], v[180:183], v[112:127]
    v_cvt_pk_bf16_f32 v190, v48, v49
    v_exp_f32 v50, v50
    v_exp_f32 v51, v51
    s_nop 0
    v_cvt_pk_bf16_f32 v191, v50, v51
    v_mfma_f32_32x32x16_bf16 a[72:87], a[88:91], v[184:187], a[72:87]
    v_fma_mix_f32 v44, v192, s82, -v58 op_sel:[0,0,0] op_sel_hi:[1,0,0]
    v_fma_mix_f32 v45, v192, s82, -v58 op_sel:[1,0,0] op_sel_hi:[1,0,0]
    v_exp_f32 v44, v44
    v_exp_f32 v45, v45
    v_fma_mix_f32 v46, v193, s82, -v58 op_sel:[0,0,0] op_sel_hi:[1,0,0]
    s_waitcnt lgkmcnt(14)
    v_mfma_f32_32x32x16_bf16 v[64:79], a[32:35], v[184:187], v[64:79]
    v_fma_mix_f32 v47, v193, s82, -v58 op_sel:[1,0,0] op_sel_hi:[1,0,0]
    v_cvt_pk_bf16_f32 v192, v44, v45
    v_exp_f32 v46, v46
    v_exp_f32 v47, v47
    v_fma_mix_f32 v48, v194, s82, -v58 op_sel:[0,0,0] op_sel_hi:[1,0,0]
    s_waitcnt lgkmcnt(12)
    v_mfma_f32_32x32x16_bf16 v[80:95], a[36:39], v[184:187], v[80:95]
    v_fma_mix_f32 v49, v194, s82, -v58 op_sel:[1,0,0] op_sel_hi:[1,0,0]
    v_cvt_pk_bf16_f32 v193, v46, v47
    v_exp_f32 v48, v48
    v_exp_f32 v49, v49
    v_fma_mix_f32 v50, v195, s82, -v58 op_sel:[0,0,0] op_sel_hi:[1,0,0]
    s_waitcnt lgkmcnt(10)
    v_mfma_f32_32x32x16_bf16 v[96:111], a[40:43], v[184:187], v[96:111]
    v_fma_mix_f32 v51, v195, s82, -v58 op_sel:[1,0,0] op_sel_hi:[1,0,0]
    v_cvt_pk_bf16_f32 v194, v48, v49
    v_exp_f32 v50, v50
    v_exp_f32 v51, v51
    v_fma_mix_f32 v44, v196, s82, -v58 op_sel:[0,0,0] op_sel_hi:[1,0,0]
    s_waitcnt lgkmcnt(8)
    v_mfma_f32_32x32x16_bf16 v[112:127], a[44:47], v[184:187], v[112:127]
    v_fma_mix_f32 v45, v196, s82, -v58 op_sel:[1,0,0] op_sel_hi:[1,0,0]
    v_cvt_pk_bf16_f32 v195, v50, v51
    v_exp_f32 v44, v44
    v_exp_f32 v45, v45
    v_fma_mix_f32 v46, v197, s82, -v58 op_sel:[0,0,0] op_sel_hi:[1,0,0]
    v_mfma_f32_32x32x16_bf16 a[72:87], a[88:91], v[188:191], a[72:87]
    v_fma_mix_f32 v47, v197, s82, -v58 op_sel:[1,0,0] op_sel_hi:[1,0,0]
    v_cvt_pk_bf16_f32 v196, v44, v45
    v_exp_f32 v46, v46
    v_exp_f32 v47, v47
    v_fma_mix_f32 v48, v198, s82, -v58 op_sel:[0,0,0] op_sel_hi:[1,0,0]
    s_waitcnt lgkmcnt(6)
    v_mfma_f32_32x32x16_bf16 v[64:79], a[48:51], v[188:191], v[64:79]
    v_fma_mix_f32 v49, v198, s82, -v58 op_sel:[1,0,0] op_sel_hi:[1,0,0]
    v_cvt_pk_bf16_f32 v197, v46, v47
    v_exp_f32 v48, v48
    v_exp_f32 v49, v49
    v_fma_mix_f32 v50, v199, s82, -v58 op_sel:[0,0,0] op_sel_hi:[1,0,0]
    s_barrier
    ds_read_b64_tr_b16 a[0:1], v32 offset:32768
    ds_read_b64_tr_b16 a[2:3], v32 offset:34816
    ds_read_b64_tr_b16 a[4:5], v33 offset:32768
    ds_read_b64_tr_b16 a[6:7], v33 offset:34816
    s_waitcnt lgkmcnt(8)
    v_mfma_f32_32x32x16_bf16 v[80:95], a[52:55], v[188:191], v[80:95]
    ds_read_b64_tr_b16 a[8:9], v34 offset:32768
    ds_read_b64_tr_b16 a[10:11], v34 offset:34816
    ds_read_b64_tr_b16 a[12:13], v35 offset:32768
    ds_read_b64_tr_b16 a[14:15], v35 offset:34816
    v_fma_mix_f32 v51, v199, s82, -v58 op_sel:[1,0,0] op_sel_hi:[1,0,0]
    v_cvt_pk_bf16_f32 v198, v48, v49
    s_waitcnt lgkmcnt(10)
    v_mfma_f32_32x32x16_bf16 v[96:111], a[56:59], v[188:191], v[96:111]
    ds_read_b64_tr_b16 a[16:17], v32 offset:36864
    ds_read_b64_tr_b16 a[18:19], v32 offset:38912
    ds_read_b64_tr_b16 a[20:21], v33 offset:36864
    ds_read_b64_tr_b16 a[22:23], v33 offset:38912
    v_exp_f32 v50, v50
    v_exp_f32 v51, v51
    s_waitcnt lgkmcnt(12)
    v_mfma_f32_32x32x16_bf16 v[112:127], a[60:63], v[188:191], v[112:127]
    ds_read_b64_tr_b16 a[24:25], v34 offset:36864
    ds_read_b64_tr_b16 a[26:27], v34 offset:38912
    ds_read_b64_tr_b16 a[28:29], v35 offset:36864
    s_waitcnt lgkmcnt(14)
    ds_read_b64_tr_b16 a[30:31], v35 offset:38912
    v_cvt_pk_bf16_f32 v199, v50, v51
    v_mfma_f32_32x32x16_bf16 a[72:87], a[88:91], v[192:195], a[72:87]
    s_waitcnt lgkmcnt(14)
    ds_read_b64_tr_b16 a[32:33], v32 offset:40960
    s_waitcnt lgkmcnt(14)
    ds_read_b64_tr_b16 a[34:35], v32 offset:43008
    v_fma_mix_f32 v44, v200, s82, -v58 op_sel:[0,0,0] op_sel_hi:[1,0,0]
    v_fma_mix_f32 v45, v200, s82, -v58 op_sel:[1,0,0] op_sel_hi:[1,0,0]
    v_exp_f32 v44, v44
    v_exp_f32 v45, v45
    v_mfma_f32_32x32x16_bf16 v[64:79], a[0:3], v[192:195], v[64:79]
    s_waitcnt lgkmcnt(14)
    ds_read_b64_tr_b16 a[36:37], v33 offset:40960
    s_waitcnt lgkmcnt(14)
    ds_read_b64_tr_b16 a[38:39], v33 offset:43008
    v_fma_mix_f32 v46, v201, s82, -v58 op_sel:[0,0,0] op_sel_hi:[1,0,0]
    v_fma_mix_f32 v47, v201, s82, -v58 op_sel:[1,0,0] op_sel_hi:[1,0,0]
    v_cvt_pk_bf16_f32 v200, v44, v45
    v_exp_f32 v46, v46
    v_mfma_f32_32x32x16_bf16 v[80:95], a[4:7], v[192:195], v[80:95]
    s_waitcnt lgkmcnt(14)
    ds_read_b64_tr_b16 a[40:41], v34 offset:40960
    s_waitcnt lgkmcnt(14)
    ds_read_b64_tr_b16 a[42:43], v34 offset:43008
    v_exp_f32 v47, v47
    v_fma_mix_f32 v48, v202, s82, -v58 op_sel:[0,0,0] op_sel_hi:[1,0,0]
    v_fma_mix_f32 v49, v202, s82, -v58 op_sel:[1,0,0] op_sel_hi:[1,0,0]
    v_cvt_pk_bf16_f32 v201, v46, v47
    v_mfma_f32_32x32x16_bf16 v[96:111], a[8:11], v[192:195], v[96:111]
    s_waitcnt lgkmcnt(14)
    ds_read_b64_tr_b16 a[44:45], v35 offset:40960
    s_waitcnt lgkmcnt(14)
    ds_read_b64_tr_b16 a[46:47], v35 offset:43008
    v_exp_f32 v48, v48
    v_exp_f32 v49, v49
    v_fma_mix_f32 v50, v203, s82, -v58 op_sel:[0,0,0] op_sel_hi:[1,0,0]
    v_fma_mix_f32 v51, v203, s82, -v58 op_sel:[1,0,0] op_sel_hi:[1,0,0]
    v_mfma_f32_32x32x16_bf16 v[112:127], a[12:15], v[192:195], v[112:127]
    s_waitcnt lgkmcnt(14)
    ds_read_b64_tr_b16 a[48:49], v32 offset:45056
    s_waitcnt lgkmcnt(14)
    ds_read_b64_tr_b16 a[50:51], v32 offset:47104
    v_cvt_pk_bf16_f32 v202, v48, v49
    v_exp_f32 v50, v50
    v_exp_f32 v51, v51
    v_fma_mix_f32 v44, v204, s82, -v58 op_sel:[0,0,0] op_sel_hi:[1,0,0]
    v_mfma_f32_32x32x16_bf16 a[72:87], a[88:91], v[196:199], a[72:87]
    s_waitcnt lgkmcnt(14)
    ds_read_b64_tr_b16 a[52:53], v33 offset:45056
    s_waitcnt lgkmcnt(14)
    ds_read_b64_tr_b16 a[54:55], v33 offset:47104
    v_fma_mix_f32 v45, v204, s82, -v58 op_sel:[1,0,0] op_sel_hi:[1,0,0]
    v_cvt_pk_bf16_f32 v203, v50, v51
    v_exp_f32 v44, v44
    v_exp_f32 v45, v45
    v_mfma_f32_32x32x16_bf16 v[64:79], a[16:19], v[196:199], v[64:79]
    s_waitcnt lgkmcnt(14)
    ds_read_b64_tr_b16 a[56:57], v34 offset:45056
    s_waitcnt lgkmcnt(14)
    ds_read_b64_tr_b16 a[58:59], v34 offset:47104
    v_fma_mix_f32 v46, v205, s82, -v58 op_sel:[0,0,0] op_sel_hi:[1,0,0]
    v_fma_mix_f32 v47, v205, s82, -v58 op_sel:[1,0,0] op_sel_hi:[1,0,0]
    v_cvt_pk_bf16_f32 v204, v44, v45
    v_exp_f32 v46, v46
    v_mfma_f32_32x32x16_bf16 v[80:95], a[20:23], v[196:199], v[80:95]
    s_waitcnt lgkmcnt(14)
    ds_read_b64_tr_b16 a[60:61], v35 offset:45056
    s_waitcnt lgkmcnt(14)
    ds_read_b64_tr_b16 a[62:63], v35 offset:47104
    v_exp_f32 v47, v47
    v_fma_mix_f32 v48, v206, s82, -v58 op_sel:[0,0,0] op_sel_hi:[1,0,0]
    v_fma_mix_f32 v49, v206, s82, -v58 op_sel:[1,0,0] op_sel_hi:[1,0,0]
    v_cvt_pk_bf16_f32 v205, v46, v47
    v_mfma_f32_32x32x16_bf16 v[96:111], a[24:27], v[196:199], v[96:111]
    v_exp_f32 v48, v48
    v_exp_f32 v49, v49
    v_fma_mix_f32 v50, v207, s82, -v58 op_sel:[0,0,0] op_sel_hi:[1,0,0]
    v_fma_mix_f32 v51, v207, s82, -v58 op_sel:[1,0,0] op_sel_hi:[1,0,0]
    v_mfma_f32_32x32x16_bf16 v[112:127], a[28:31], v[196:199], v[112:127]
    v_cvt_pk_bf16_f32 v206, v48, v49
    v_exp_f32 v50, v50
    v_exp_f32 v51, v51
    s_nop 0
    v_cvt_pk_bf16_f32 v207, v50, v51
    v_mfma_f32_32x32x16_bf16 a[72:87], a[88:91], v[200:203], a[72:87]
    v_fma_mix_f32 v44, v208, s82, -v58 op_sel:[0,0,0] op_sel_hi:[1,0,0]
    v_fma_mix_f32 v45, v208, s82, -v58 op_sel:[1,0,0] op_sel_hi:[1,0,0]
    v_exp_f32 v44, v44
    v_exp_f32 v45, v45
    v_fma_mix_f32 v46, v209, s82, -v58 op_sel:[0,0,0] op_sel_hi:[1,0,0]
    s_waitcnt lgkmcnt(14)
    v_mfma_f32_32x32x16_bf16 v[64:79], a[32:35], v[200:203], v[64:79]
    v_fma_mix_f32 v47, v209, s82, -v58 op_sel:[1,0,0] op_sel_hi:[1,0,0]
    v_cvt_pk_bf16_f32 v208, v44, v45
    v_exp_f32 v46, v46
    v_exp_f32 v47, v47
    v_fma_mix_f32 v48, v210, s82, -v58 op_sel:[0,0,0] op_sel_hi:[1,0,0]
    s_waitcnt lgkmcnt(12)
    v_mfma_f32_32x32x16_bf16 v[80:95], a[36:39], v[200:203], v[80:95]
    v_fma_mix_f32 v49, v210, s82, -v58 op_sel:[1,0,0] op_sel_hi:[1,0,0]
    v_cvt_pk_bf16_f32 v209, v46, v47
    v_exp_f32 v48, v48
    v_exp_f32 v49, v49
    v_fma_mix_f32 v50, v211, s82, -v58 op_sel:[0,0,0] op_sel_hi:[1,0,0]
    s_waitcnt lgkmcnt(10)
    v_mfma_f32_32x32x16_bf16 v[96:111], a[40:43], v[200:203], v[96:111]
    v_fma_mix_f32 v51, v211, s82, -v58 op_sel:[1,0,0] op_sel_hi:[1,0,0]
    v_cvt_pk_bf16_f32 v210, v48, v49
    v_exp_f32 v50, v50
    v_exp_f32 v51, v51
    v_fma_mix_f32 v44, v212, s82, -v58 op_sel:[0,0,0] op_sel_hi:[1,0,0]
    s_waitcnt lgkmcnt(8)
    v_mfma_f32_32x32x16_bf16 v[112:127], a[44:47], v[200:203], v[112:127]
    v_fma_mix_f32 v45, v212, s82, -v58 op_sel:[1,0,0] op_sel_hi:[1,0,0]
    v_cvt_pk_bf16_f32 v211, v50, v51
    v_exp_f32 v44, v44
    v_exp_f32 v45, v45
    v_fma_mix_f32 v46, v213, s82, -v58 op_sel:[0,0,0] op_sel_hi:[1,0,0]
    v_mfma_f32_32x32x16_bf16 a[72:87], a[88:91], v[204:207], a[72:87]
    v_fma_mix_f32 v47, v213, s82, -v58 op_sel:[1,0,0] op_sel_hi:[1,0,0]
    v_cvt_pk_bf16_f32 v212, v44, v45
    v_exp_f32 v46, v46
    v_exp_f32 v47, v47
    v_fma_mix_f32 v48, v214, s82, -v58 op_sel:[0,0,0] op_sel_hi:[1,0,0]
    s_waitcnt lgkmcnt(6)
    v_mfma_f32_32x32x16_bf16 v[64:79], a[48:51], v[204:207], v[64:79]
    v_fma_mix_f32 v49, v214, s82, -v58 op_sel:[1,0,0] op_sel_hi:[1,0,0]
    v_cvt_pk_bf16_f32 v213, v46, v47
    v_exp_f32 v48, v48
    v_exp_f32 v49, v49
    v_fma_mix_f32 v50, v215, s82, -v58 op_sel:[0,0,0] op_sel_hi:[1,0,0]
    s_barrier
    ds_read_b64_tr_b16 a[0:1], v32 offset:49152
    ds_read_b64_tr_b16 a[2:3], v32 offset:51200
    ds_read_b64_tr_b16 a[4:5], v33 offset:49152
    ds_read_b64_tr_b16 a[6:7], v33 offset:51200
    s_waitcnt lgkmcnt(8)
    v_mfma_f32_32x32x16_bf16 v[80:95], a[52:55], v[204:207], v[80:95]
    ds_read_b64_tr_b16 a[8:9], v34 offset:49152
    ds_read_b64_tr_b16 a[10:11], v34 offset:51200
    ds_read_b64_tr_b16 a[12:13], v35 offset:49152
    ds_read_b64_tr_b16 a[14:15], v35 offset:51200
    v_fma_mix_f32 v51, v215, s82, -v58 op_sel:[1,0,0] op_sel_hi:[1,0,0]
    v_cvt_pk_bf16_f32 v214, v48, v49
    s_waitcnt lgkmcnt(10)
    v_mfma_f32_32x32x16_bf16 v[96:111], a[56:59], v[204:207], v[96:111]
    ds_read_b64_tr_b16 a[16:17], v32 offset:53248
    ds_read_b64_tr_b16 a[18:19], v32 offset:55296
    ds_read_b64_tr_b16 a[20:21], v33 offset:53248
    ds_read_b64_tr_b16 a[22:23], v33 offset:55296
    v_exp_f32 v50, v50
    v_exp_f32 v51, v51
    s_waitcnt lgkmcnt(12)
    v_mfma_f32_32x32x16_bf16 v[112:127], a[60:63], v[204:207], v[112:127]
    ds_read_b64_tr_b16 a[24:25], v34 offset:53248
    ds_read_b64_tr_b16 a[26:27], v34 offset:55296
    ds_read_b64_tr_b16 a[28:29], v35 offset:53248
    s_waitcnt lgkmcnt(14)
    ds_read_b64_tr_b16 a[30:31], v35 offset:55296
    v_cvt_pk_bf16_f32 v215, v50, v51
    v_mfma_f32_32x32x16_bf16 a[72:87], a[88:91], v[208:211], a[72:87]
    s_waitcnt lgkmcnt(14)
    ds_read_b64_tr_b16 a[32:33], v32 offset:57344
    s_waitcnt lgkmcnt(14)
    ds_read_b64_tr_b16 a[34:35], v32 offset:59392
    v_fma_mix_f32 v44, v216, s82, -v58 op_sel:[0,0,0] op_sel_hi:[1,0,0]
    v_fma_mix_f32 v45, v216, s82, -v58 op_sel:[1,0,0] op_sel_hi:[1,0,0]
    v_exp_f32 v44, v44
    v_exp_f32 v45, v45
    v_mfma_f32_32x32x16_bf16 v[64:79], a[0:3], v[208:211], v[64:79]
    s_waitcnt lgkmcnt(14)
    ds_read_b64_tr_b16 a[36:37], v33 offset:57344
    s_waitcnt lgkmcnt(14)
    ds_read_b64_tr_b16 a[38:39], v33 offset:59392
    v_fma_mix_f32 v46, v217, s82, -v58 op_sel:[0,0,0] op_sel_hi:[1,0,0]
    v_fma_mix_f32 v47, v217, s82, -v58 op_sel:[1,0,0] op_sel_hi:[1,0,0]
    v_cvt_pk_bf16_f32 v216, v44, v45
    v_exp_f32 v46, v46
    v_mfma_f32_32x32x16_bf16 v[80:95], a[4:7], v[208:211], v[80:95]
    s_waitcnt lgkmcnt(14)
    ds_read_b64_tr_b16 a[40:41], v34 offset:57344
    s_waitcnt lgkmcnt(14)
    ds_read_b64_tr_b16 a[42:43], v34 offset:59392
    v_exp_f32 v47, v47
    v_fma_mix_f32 v48, v218, s82, -v58 op_sel:[0,0,0] op_sel_hi:[1,0,0]
    v_fma_mix_f32 v49, v218, s82, -v58 op_sel:[1,0,0] op_sel_hi:[1,0,0]
    v_cvt_pk_bf16_f32 v217, v46, v47
    v_mfma_f32_32x32x16_bf16 v[96:111], a[8:11], v[208:211], v[96:111]
    s_waitcnt lgkmcnt(14)
    ds_read_b64_tr_b16 a[44:45], v35 offset:57344
    s_waitcnt lgkmcnt(14)
    ds_read_b64_tr_b16 a[46:47], v35 offset:59392
    v_exp_f32 v48, v48
    v_exp_f32 v49, v49
    v_fma_mix_f32 v50, v219, s82, -v58 op_sel:[0,0,0] op_sel_hi:[1,0,0]
    v_fma_mix_f32 v51, v219, s82, -v58 op_sel:[1,0,0] op_sel_hi:[1,0,0]
    v_mfma_f32_32x32x16_bf16 v[112:127], a[12:15], v[208:211], v[112:127]
    s_waitcnt lgkmcnt(14)
    ds_read_b64_tr_b16 a[48:49], v32 offset:61440
    s_waitcnt lgkmcnt(14)
    ds_read_b64_tr_b16 a[50:51], v32 offset:63488
    v_cvt_pk_bf16_f32 v218, v48, v49
    v_exp_f32 v50, v50
    v_exp_f32 v51, v51
    v_fma_mix_f32 v44, v220, s82, -v58 op_sel:[0,0,0] op_sel_hi:[1,0,0]
    v_mfma_f32_32x32x16_bf16 a[72:87], a[88:91], v[212:215], a[72:87]
    s_waitcnt lgkmcnt(14)
    ds_read_b64_tr_b16 a[52:53], v33 offset:61440
    s_waitcnt lgkmcnt(14)
    ds_read_b64_tr_b16 a[54:55], v33 offset:63488
    v_fma_mix_f32 v45, v220, s82, -v58 op_sel:[1,0,0] op_sel_hi:[1,0,0]
    v_cvt_pk_bf16_f32 v219, v50, v51
    v_exp_f32 v44, v44
    v_exp_f32 v45, v45
    v_mfma_f32_32x32x16_bf16 v[64:79], a[16:19], v[212:215], v[64:79]
    s_waitcnt lgkmcnt(14)
    ds_read_b64_tr_b16 a[56:57], v34 offset:61440
    s_waitcnt lgkmcnt(14)
    ds_read_b64_tr_b16 a[58:59], v34 offset:63488
    v_fma_mix_f32 v46, v221, s82, -v58 op_sel:[0,0,0] op_sel_hi:[1,0,0]
    v_fma_mix_f32 v47, v221, s82, -v58 op_sel:[1,0,0] op_sel_hi:[1,0,0]
    v_cvt_pk_bf16_f32 v220, v44, v45
    v_exp_f32 v46, v46
    v_mfma_f32_32x32x16_bf16 v[80:95], a[20:23], v[212:215], v[80:95]
    s_waitcnt lgkmcnt(14)
    ds_read_b64_tr_b16 a[60:61], v35 offset:61440
    s_waitcnt lgkmcnt(14)
    ds_read_b64_tr_b16 a[62:63], v35 offset:63488
    v_exp_f32 v47, v47
    v_fma_mix_f32 v48, v222, s82, -v58 op_sel:[0,0,0] op_sel_hi:[1,0,0]
    v_fma_mix_f32 v49, v222, s82, -v58 op_sel:[1,0,0] op_sel_hi:[1,0,0]
    v_cvt_pk_bf16_f32 v221, v46, v47
    v_mfma_f32_32x32x16_bf16 v[96:111], a[24:27], v[212:215], v[96:111]
    v_exp_f32 v48, v48
    v_exp_f32 v49, v49
    v_fma_mix_f32 v50, v223, s82, -v58 op_sel:[0,0,0] op_sel_hi:[1,0,0]
    v_fma_mix_f32 v51, v223, s82, -v58 op_sel:[1,0,0] op_sel_hi:[1,0,0]
    v_mfma_f32_32x32x16_bf16 v[112:127], a[28:31], v[212:215], v[112:127]
    v_cvt_pk_bf16_f32 v222, v48, v49
    v_exp_f32 v50, v50
    v_exp_f32 v51, v51
    s_nop 0
    v_cvt_pk_bf16_f32 v223, v50, v51
    v_mfma_f32_32x32x16_bf16 a[72:87], a[88:91], v[216:219], a[72:87]
    v_fma_mix_f32 v44, v224, s82, -v58 op_sel:[0,0,0] op_sel_hi:[1,0,0]
    v_fma_mix_f32 v45, v224, s82, -v58 op_sel:[1,0,0] op_sel_hi:[1,0,0]
    v_exp_f32 v44, v44
    v_exp_f32 v45, v45
    v_fma_mix_f32 v46, v225, s82, -v58 op_sel:[0,0,0] op_sel_hi:[1,0,0]
    s_waitcnt lgkmcnt(14)
    v_mfma_f32_32x32x16_bf16 v[64:79], a[32:35], v[216:219], v[64:79]
    v_fma_mix_f32 v47, v225, s82, -v58 op_sel:[1,0,0] op_sel_hi:[1,0,0]
    v_cvt_pk_bf16_f32 v224, v44, v45
    v_exp_f32 v46, v46
    v_exp_f32 v47, v47
    v_fma_mix_f32 v48, v226, s82, -v58 op_sel:[0,0,0] op_sel_hi:[1,0,0]
    s_waitcnt lgkmcnt(12)
    v_mfma_f32_32x32x16_bf16 v[80:95], a[36:39], v[216:219], v[80:95]
    v_fma_mix_f32 v49, v226, s82, -v58 op_sel:[1,0,0] op_sel_hi:[1,0,0]
    v_cvt_pk_bf16_f32 v225, v46, v47
    v_exp_f32 v48, v48
    v_exp_f32 v49, v49
    v_fma_mix_f32 v50, v227, s82, -v58 op_sel:[0,0,0] op_sel_hi:[1,0,0]
    s_waitcnt lgkmcnt(10)
    v_mfma_f32_32x32x16_bf16 v[96:111], a[40:43], v[216:219], v[96:111]
    v_fma_mix_f32 v51, v227, s82, -v58 op_sel:[1,0,0] op_sel_hi:[1,0,0]
    v_cvt_pk_bf16_f32 v226, v48, v49
    v_exp_f32 v50, v50
    v_exp_f32 v51, v51
    v_fma_mix_f32 v44, v228, s82, -v58 op_sel:[0,0,0] op_sel_hi:[1,0,0]
    s_waitcnt lgkmcnt(8)
    v_mfma_f32_32x32x16_bf16 v[112:127], a[44:47], v[216:219], v[112:127]
    v_fma_mix_f32 v45, v228, s82, -v58 op_sel:[1,0,0] op_sel_hi:[1,0,0]
    v_cvt_pk_bf16_f32 v227, v50, v51
    v_exp_f32 v44, v44
    v_exp_f32 v45, v45
    v_fma_mix_f32 v46, v229, s82, -v58 op_sel:[0,0,0] op_sel_hi:[1,0,0]
    v_mfma_f32_32x32x16_bf16 a[72:87], a[88:91], v[220:223], a[72:87]
    v_fma_mix_f32 v47, v229, s82, -v58 op_sel:[1,0,0] op_sel_hi:[1,0,0]
    v_cvt_pk_bf16_f32 v228, v44, v45
    v_exp_f32 v46, v46
    v_exp_f32 v47, v47
    v_fma_mix_f32 v48, v230, s82, -v58 op_sel:[0,0,0] op_sel_hi:[1,0,0]
    s_waitcnt lgkmcnt(6)
    v_mfma_f32_32x32x16_bf16 v[64:79], a[48:51], v[220:223], v[64:79]
    v_fma_mix_f32 v49, v230, s82, -v58 op_sel:[1,0,0] op_sel_hi:[1,0,0]
    v_cvt_pk_bf16_f32 v229, v46, v47
    v_exp_f32 v48, v48
    v_exp_f32 v49, v49
    v_fma_mix_f32 v50, v231, s82, -v58 op_sel:[0,0,0] op_sel_hi:[1,0,0]
    s_barrier
    ds_read_b64_tr_b16 a[0:1], v36 offset:0
    ds_read_b64_tr_b16 a[2:3], v36 offset:2048
    ds_read_b64_tr_b16 a[4:5], v37 offset:0
    ds_read_b64_tr_b16 a[6:7], v37 offset:2048
    s_waitcnt lgkmcnt(8)
    v_mfma_f32_32x32x16_bf16 v[80:95], a[52:55], v[220:223], v[80:95]
    ds_read_b64_tr_b16 a[8:9], v38 offset:0
    ds_read_b64_tr_b16 a[10:11], v38 offset:2048
    ds_read_b64_tr_b16 a[12:13], v39 offset:0
    ds_read_b64_tr_b16 a[14:15], v39 offset:2048
    v_fma_mix_f32 v51, v231, s82, -v58 op_sel:[1,0,0] op_sel_hi:[1,0,0]
    v_cvt_pk_bf16_f32 v230, v48, v49
    s_waitcnt lgkmcnt(10)
    v_mfma_f32_32x32x16_bf16 v[96:111], a[56:59], v[220:223], v[96:111]
    ds_read_b64_tr_b16 a[16:17], v36 offset:4096
    ds_read_b64_tr_b16 a[18:19], v36 offset:6144
    ds_read_b64_tr_b16 a[20:21], v37 offset:4096
    ds_read_b64_tr_b16 a[22:23], v37 offset:6144
    v_exp_f32 v50, v50
    v_exp_f32 v51, v51
    s_waitcnt lgkmcnt(12)
    v_mfma_f32_32x32x16_bf16 v[112:127], a[60:63], v[220:223], v[112:127]
    ds_read_b64_tr_b16 a[24:25], v38 offset:4096
    ds_read_b64_tr_b16 a[26:27], v38 offset:6144
    ds_read_b64_tr_b16 a[28:29], v39 offset:4096
    s_waitcnt lgkmcnt(14)
    ds_read_b64_tr_b16 a[30:31], v39 offset:6144
    v_cvt_pk_bf16_f32 v231, v50, v51
    v_mfma_f32_32x32x16_bf16 a[72:87], a[88:91], v[224:227], a[72:87]
    s_waitcnt lgkmcnt(14)
    ds_read_b64_tr_b16 a[32:33], v36 offset:8192
    s_waitcnt lgkmcnt(14)
    ds_read_b64_tr_b16 a[34:35], v36 offset:10240
    v_fma_mix_f32 v44, v232, s82, -v58 op_sel:[0,0,0] op_sel_hi:[1,0,0]
    v_fma_mix_f32 v45, v232, s82, -v58 op_sel:[1,0,0] op_sel_hi:[1,0,0]
    v_exp_f32 v44, v44
    v_exp_f32 v45, v45
    v_mfma_f32_32x32x16_bf16 v[64:79], a[0:3], v[224:227], v[64:79]
    s_waitcnt lgkmcnt(14)
    ds_read_b64_tr_b16 a[36:37], v37 offset:8192
    s_waitcnt lgkmcnt(14)
    ds_read_b64_tr_b16 a[38:39], v37 offset:10240
    v_fma_mix_f32 v46, v233, s82, -v58 op_sel:[0,0,0] op_sel_hi:[1,0,0]
    v_fma_mix_f32 v47, v233, s82, -v58 op_sel:[1,0,0] op_sel_hi:[1,0,0]
    v_cvt_pk_bf16_f32 v232, v44, v45
    v_exp_f32 v46, v46
    v_mfma_f32_32x32x16_bf16 v[80:95], a[4:7], v[224:227], v[80:95]
    s_waitcnt lgkmcnt(14)
    ds_read_b64_tr_b16 a[40:41], v38 offset:8192
    s_waitcnt lgkmcnt(14)
    ds_read_b64_tr_b16 a[42:43], v38 offset:10240
    v_exp_f32 v47, v47
    v_fma_mix_f32 v48, v234, s82, -v58 op_sel:[0,0,0] op_sel_hi:[1,0,0]
    v_fma_mix_f32 v49, v234, s82, -v58 op_sel:[1,0,0] op_sel_hi:[1,0,0]
    v_cvt_pk_bf16_f32 v233, v46, v47
    v_mfma_f32_32x32x16_bf16 v[96:111], a[8:11], v[224:227], v[96:111]
    s_waitcnt lgkmcnt(14)
    ds_read_b64_tr_b16 a[44:45], v39 offset:8192
    s_waitcnt lgkmcnt(14)
    ds_read_b64_tr_b16 a[46:47], v39 offset:10240
    v_exp_f32 v48, v48
    v_exp_f32 v49, v49
    v_fma_mix_f32 v50, v235, s82, -v58 op_sel:[0,0,0] op_sel_hi:[1,0,0]
    v_fma_mix_f32 v51, v235, s82, -v58 op_sel:[1,0,0] op_sel_hi:[1,0,0]
    v_mfma_f32_32x32x16_bf16 v[112:127], a[12:15], v[224:227], v[112:127]
    s_waitcnt lgkmcnt(14)
    ds_read_b64_tr_b16 a[48:49], v36 offset:12288
    s_waitcnt lgkmcnt(14)
    ds_read_b64_tr_b16 a[50:51], v36 offset:14336
    v_cvt_pk_bf16_f32 v234, v48, v49
    v_exp_f32 v50, v50
    v_exp_f32 v51, v51
    v_fma_mix_f32 v44, v236, s82, -v58 op_sel:[0,0,0] op_sel_hi:[1,0,0]
    v_mfma_f32_32x32x16_bf16 a[72:87], a[88:91], v[228:231], a[72:87]
    s_waitcnt lgkmcnt(14)
    ds_read_b64_tr_b16 a[52:53], v37 offset:12288
    s_waitcnt lgkmcnt(14)
    ds_read_b64_tr_b16 a[54:55], v37 offset:14336
    v_fma_mix_f32 v45, v236, s82, -v58 op_sel:[1,0,0] op_sel_hi:[1,0,0]
    v_cvt_pk_bf16_f32 v235, v50, v51
    v_exp_f32 v44, v44
    v_exp_f32 v45, v45
    v_mfma_f32_32x32x16_bf16 v[64:79], a[16:19], v[228:231], v[64:79]
    s_waitcnt lgkmcnt(14)
    ds_read_b64_tr_b16 a[56:57], v38 offset:12288
    s_waitcnt lgkmcnt(14)
    ds_read_b64_tr_b16 a[58:59], v38 offset:14336
    v_fma_mix_f32 v46, v237, s82, -v58 op_sel:[0,0,0] op_sel_hi:[1,0,0]
    v_fma_mix_f32 v47, v237, s82, -v58 op_sel:[1,0,0] op_sel_hi:[1,0,0]
    v_cvt_pk_bf16_f32 v236, v44, v45
    v_exp_f32 v46, v46
    v_mfma_f32_32x32x16_bf16 v[80:95], a[20:23], v[228:231], v[80:95]
    s_waitcnt lgkmcnt(14)
    ds_read_b64_tr_b16 a[60:61], v39 offset:12288
    s_waitcnt lgkmcnt(14)
    ds_read_b64_tr_b16 a[62:63], v39 offset:14336
    v_exp_f32 v47, v47
    v_fma_mix_f32 v48, v238, s82, -v58 op_sel:[0,0,0] op_sel_hi:[1,0,0]
    v_fma_mix_f32 v49, v238, s82, -v58 op_sel:[1,0,0] op_sel_hi:[1,0,0]
    v_cvt_pk_bf16_f32 v237, v46, v47
    v_mfma_f32_32x32x16_bf16 v[96:111], a[24:27], v[228:231], v[96:111]
    v_exp_f32 v48, v48
    v_exp_f32 v49, v49
    v_fma_mix_f32 v50, v239, s82, -v58 op_sel:[0,0,0] op_sel_hi:[1,0,0]
    v_fma_mix_f32 v51, v239, s82, -v58 op_sel:[1,0,0] op_sel_hi:[1,0,0]
    v_mfma_f32_32x32x16_bf16 v[112:127], a[28:31], v[228:231], v[112:127]
    v_cvt_pk_bf16_f32 v238, v48, v49
    v_exp_f32 v50, v50
    v_exp_f32 v51, v51
    s_nop 0
    v_cvt_pk_bf16_f32 v239, v50, v51
    v_mfma_f32_32x32x16_bf16 a[72:87], a[88:91], v[232:235], a[72:87]
    v_fma_mix_f32 v44, v240, s82, -v58 op_sel:[0,0,0] op_sel_hi:[1,0,0]
    v_fma_mix_f32 v45, v240, s82, -v58 op_sel:[1,0,0] op_sel_hi:[1,0,0]
    v_exp_f32 v44, v44
    v_exp_f32 v45, v45
    v_fma_mix_f32 v46, v241, s82, -v58 op_sel:[0,0,0] op_sel_hi:[1,0,0]
    s_waitcnt lgkmcnt(14)
    v_mfma_f32_32x32x16_bf16 v[64:79], a[32:35], v[232:235], v[64:79]
    v_fma_mix_f32 v47, v241, s82, -v58 op_sel:[1,0,0] op_sel_hi:[1,0,0]
    v_cvt_pk_bf16_f32 v240, v44, v45
    v_exp_f32 v46, v46
    v_exp_f32 v47, v47
    v_fma_mix_f32 v48, v242, s82, -v58 op_sel:[0,0,0] op_sel_hi:[1,0,0]
    s_waitcnt lgkmcnt(12)
    v_mfma_f32_32x32x16_bf16 v[80:95], a[36:39], v[232:235], v[80:95]
    v_fma_mix_f32 v49, v242, s82, -v58 op_sel:[1,0,0] op_sel_hi:[1,0,0]
    v_cvt_pk_bf16_f32 v241, v46, v47
    v_exp_f32 v48, v48
    v_exp_f32 v49, v49
    v_fma_mix_f32 v50, v243, s82, -v58 op_sel:[0,0,0] op_sel_hi:[1,0,0]
    s_waitcnt lgkmcnt(10)
    v_mfma_f32_32x32x16_bf16 v[96:111], a[40:43], v[232:235], v[96:111]
    v_fma_mix_f32 v51, v243, s82, -v58 op_sel:[1,0,0] op_sel_hi:[1,0,0]
    v_cvt_pk_bf16_f32 v242, v48, v49
    v_exp_f32 v50, v50
    v_exp_f32 v51, v51
    v_fma_mix_f32 v44, v244, s82, -v58 op_sel:[0,0,0] op_sel_hi:[1,0,0]
    s_waitcnt lgkmcnt(8)
    v_mfma_f32_32x32x16_bf16 v[112:127], a[44:47], v[232:235], v[112:127]
    v_fma_mix_f32 v45, v244, s82, -v58 op_sel:[1,0,0] op_sel_hi:[1,0,0]
    v_cvt_pk_bf16_f32 v243, v50, v51
    v_exp_f32 v44, v44
    v_exp_f32 v45, v45
    v_fma_mix_f32 v46, v245, s82, -v58 op_sel:[0,0,0] op_sel_hi:[1,0,0]
    v_mfma_f32_32x32x16_bf16 a[72:87], a[88:91], v[236:239], a[72:87]
    v_fma_mix_f32 v47, v245, s82, -v58 op_sel:[1,0,0] op_sel_hi:[1,0,0]
    v_cvt_pk_bf16_f32 v244, v44, v45
    v_exp_f32 v46, v46
    v_exp_f32 v47, v47
    v_fma_mix_f32 v48, v246, s82, -v58 op_sel:[0,0,0] op_sel_hi:[1,0,0]
    s_waitcnt lgkmcnt(6)
    v_mfma_f32_32x32x16_bf16 v[64:79], a[48:51], v[236:239], v[64:79]
    v_fma_mix_f32 v49, v246, s82, -v58 op_sel:[1,0,0] op_sel_hi:[1,0,0]
    v_cvt_pk_bf16_f32 v245, v46, v47
    v_exp_f32 v48, v48
    v_exp_f32 v49, v49
    v_fma_mix_f32 v50, v247, s82, -v58 op_sel:[0,0,0] op_sel_hi:[1,0,0]
    s_barrier
    ds_read_b64_tr_b16 a[0:1], v36 offset:16384
    ds_read_b64_tr_b16 a[2:3], v36 offset:18432
    ds_read_b64_tr_b16 a[4:5], v37 offset:16384
    ds_read_b64_tr_b16 a[6:7], v37 offset:18432
    s_waitcnt lgkmcnt(8)
    v_mfma_f32_32x32x16_bf16 v[80:95], a[52:55], v[236:239], v[80:95]
    ds_read_b64_tr_b16 a[8:9], v38 offset:16384
    ds_read_b64_tr_b16 a[10:11], v38 offset:18432
    ds_read_b64_tr_b16 a[12:13], v39 offset:16384
    ds_read_b64_tr_b16 a[14:15], v39 offset:18432
    v_fma_mix_f32 v51, v247, s82, -v58 op_sel:[1,0,0] op_sel_hi:[1,0,0]
    v_cvt_pk_bf16_f32 v246, v48, v49
    s_waitcnt lgkmcnt(10)
    v_mfma_f32_32x32x16_bf16 v[96:111], a[56:59], v[236:239], v[96:111]
    ds_read_b64_tr_b16 a[16:17], v36 offset:20480
    ds_read_b64_tr_b16 a[18:19], v36 offset:22528
    ds_read_b64_tr_b16 a[20:21], v37 offset:20480
    ds_read_b64_tr_b16 a[22:23], v37 offset:22528
    v_exp_f32 v50, v50
    v_exp_f32 v51, v51
    s_waitcnt lgkmcnt(12)
    v_mfma_f32_32x32x16_bf16 v[112:127], a[60:63], v[236:239], v[112:127]
    ds_read_b64_tr_b16 a[24:25], v38 offset:20480
    ds_read_b64_tr_b16 a[26:27], v38 offset:22528
    ds_read_b64_tr_b16 a[28:29], v39 offset:20480
    s_waitcnt lgkmcnt(14)
    ds_read_b64_tr_b16 a[30:31], v39 offset:22528
    v_cvt_pk_bf16_f32 v247, v50, v51
    v_mfma_f32_32x32x16_bf16 a[72:87], a[88:91], v[240:243], a[72:87]
    s_waitcnt lgkmcnt(14)
    ds_read_b64_tr_b16 a[32:33], v36 offset:24576
    s_waitcnt lgkmcnt(14)
    ds_read_b64_tr_b16 a[34:35], v36 offset:26624
    v_fma_mix_f32 v44, v248, s82, -v58 op_sel:[0,0,0] op_sel_hi:[1,0,0]
    v_fma_mix_f32 v45, v248, s82, -v58 op_sel:[1,0,0] op_sel_hi:[1,0,0]
    v_exp_f32 v44, v44
    v_exp_f32 v45, v45
    v_mfma_f32_32x32x16_bf16 v[64:79], a[0:3], v[240:243], v[64:79]
    s_waitcnt lgkmcnt(14)
    ds_read_b64_tr_b16 a[36:37], v37 offset:24576
    s_waitcnt lgkmcnt(14)
    ds_read_b64_tr_b16 a[38:39], v37 offset:26624
    v_fma_mix_f32 v46, v249, s82, -v58 op_sel:[0,0,0] op_sel_hi:[1,0,0]
    v_fma_mix_f32 v47, v249, s82, -v58 op_sel:[1,0,0] op_sel_hi:[1,0,0]
    v_cvt_pk_bf16_f32 v248, v44, v45
    v_exp_f32 v46, v46
    v_mfma_f32_32x32x16_bf16 v[80:95], a[4:7], v[240:243], v[80:95]
    s_waitcnt lgkmcnt(14)
    ds_read_b64_tr_b16 a[40:41], v38 offset:24576
    s_waitcnt lgkmcnt(14)
    ds_read_b64_tr_b16 a[42:43], v38 offset:26624
    v_exp_f32 v47, v47
    v_fma_mix_f32 v48, v250, s82, -v58 op_sel:[0,0,0] op_sel_hi:[1,0,0]
    v_fma_mix_f32 v49, v250, s82, -v58 op_sel:[1,0,0] op_sel_hi:[1,0,0]
    v_cvt_pk_bf16_f32 v249, v46, v47
    v_mfma_f32_32x32x16_bf16 v[96:111], a[8:11], v[240:243], v[96:111]
    s_waitcnt lgkmcnt(14)
    ds_read_b64_tr_b16 a[44:45], v39 offset:24576
    s_waitcnt lgkmcnt(14)
    ds_read_b64_tr_b16 a[46:47], v39 offset:26624
    v_exp_f32 v48, v48
    v_exp_f32 v49, v49
    v_fma_mix_f32 v50, v251, s82, -v58 op_sel:[0,0,0] op_sel_hi:[1,0,0]
    v_fma_mix_f32 v51, v251, s82, -v58 op_sel:[1,0,0] op_sel_hi:[1,0,0]
    v_mfma_f32_32x32x16_bf16 v[112:127], a[12:15], v[240:243], v[112:127]
    s_waitcnt lgkmcnt(14)
    ds_read_b64_tr_b16 a[48:49], v36 offset:28672
    s_waitcnt lgkmcnt(14)
    ds_read_b64_tr_b16 a[50:51], v36 offset:30720
    v_cvt_pk_bf16_f32 v250, v48, v49
    v_exp_f32 v50, v50
    v_exp_f32 v51, v51
    v_fma_mix_f32 v44, v252, s82, -v58 op_sel:[0,0,0] op_sel_hi:[1,0,0]
    v_mfma_f32_32x32x16_bf16 a[72:87], a[88:91], v[244:247], a[72:87]
    s_waitcnt lgkmcnt(14)
    ds_read_b64_tr_b16 a[52:53], v37 offset:28672
    s_waitcnt lgkmcnt(14)
    ds_read_b64_tr_b16 a[54:55], v37 offset:30720
    v_fma_mix_f32 v45, v252, s82, -v58 op_sel:[1,0,0] op_sel_hi:[1,0,0]
    v_cvt_pk_bf16_f32 v251, v50, v51
    v_exp_f32 v44, v44
    v_exp_f32 v45, v45
    v_mfma_f32_32x32x16_bf16 v[64:79], a[16:19], v[244:247], v[64:79]
    s_waitcnt lgkmcnt(14)
    ds_read_b64_tr_b16 a[56:57], v38 offset:28672
    s_waitcnt lgkmcnt(14)
    ds_read_b64_tr_b16 a[58:59], v38 offset:30720
    v_fma_mix_f32 v46, v253, s82, -v58 op_sel:[0,0,0] op_sel_hi:[1,0,0]
    v_fma_mix_f32 v47, v253, s82, -v58 op_sel:[1,0,0] op_sel_hi:[1,0,0]
    v_cvt_pk_bf16_f32 v252, v44, v45
    v_exp_f32 v46, v46
    v_mfma_f32_32x32x16_bf16 v[80:95], a[20:23], v[244:247], v[80:95]
    s_waitcnt lgkmcnt(14)
    ds_read_b64_tr_b16 a[60:61], v39 offset:28672
    s_waitcnt lgkmcnt(14)
    ds_read_b64_tr_b16 a[62:63], v39 offset:30720
    v_exp_f32 v47, v47
    v_fma_mix_f32 v48, v254, s82, -v58 op_sel:[0,0,0] op_sel_hi:[1,0,0]
    v_fma_mix_f32 v49, v254, s82, -v58 op_sel:[1,0,0] op_sel_hi:[1,0,0]
    v_cvt_pk_bf16_f32 v253, v46, v47
    v_mfma_f32_32x32x16_bf16 v[96:111], a[24:27], v[244:247], v[96:111]
    v_exp_f32 v48, v48
    v_exp_f32 v49, v49
    v_fma_mix_f32 v50, v255, s82, -v58 op_sel:[0,0,0] op_sel_hi:[1,0,0]
    v_fma_mix_f32 v51, v255, s82, -v58 op_sel:[1,0,0] op_sel_hi:[1,0,0]
    v_mfma_f32_32x32x16_bf16 v[112:127], a[28:31], v[244:247], v[112:127]
    v_cvt_pk_bf16_f32 v254, v48, v49
    v_exp_f32 v50, v50
    v_exp_f32 v51, v51
    s_nop 0
    v_cvt_pk_bf16_f32 v255, v50, v51
    v_mfma_f32_32x32x16_bf16 a[72:87], a[88:91], v[248:251], a[72:87]
    s_nop 0
    v_mfma_f32_32x32x16_bf16 a[72:87], a[88:91], v[252:255], a[72:87]
    s_waitcnt lgkmcnt(14)
    v_mfma_f32_32x32x16_bf16 v[64:79], a[32:35], v[248:251], v[64:79]
    s_waitcnt lgkmcnt(6)
    v_mfma_f32_32x32x16_bf16 v[64:79], a[48:51], v[252:255], v[64:79]
    v_mfma_f32_32x32x16_bf16 v[80:95], a[36:39], v[248:251], v[80:95]
    s_nop 6
    v_accvgpr_read_b32 v60, a72
    v_rcp_f32 v60, v60
    s_waitcnt lgkmcnt(4)
    v_mfma_f32_32x32x16_bf16 v[80:95], a[52:55], v[252:255], v[80:95]
    v_mov_b32 v61, v60
    v_mfma_f32_32x32x16_bf16 v[96:111], a[40:43], v[248:251], v[96:111]
    v_mul_f32 v64, v64, v60
    v_mul_f32 v65, v65, v60
    v_mul_f32 v66, v66, v60
    v_mul_f32 v67, v67, v60
    v_mul_f32 v68, v68, v60
    v_mul_f32 v69, v69, v60
    s_waitcnt lgkmcnt(2)
    v_mfma_f32_32x32x16_bf16 v[96:111], a[56:59], v[252:255], v[96:111]
    v_mul_f32 v70, v70, v60
    v_mul_f32 v71, v71, v60
    v_cvt_pk_bf16_f32 v64, v64, v65
    v_cvt_pk_bf16_f32 v65, v66, v67
    v_cvt_pk_bf16_f32 v66, v68, v69
    v_cvt_pk_bf16_f32 v67, v70, v71
    v_mfma_f32_32x32x16_bf16 v[112:127], a[44:47], v[248:251], v[112:127]
    s_mov_b32 s72, 0
    buffer_store_dwordx4 v[64:67], v63, s[28:31], s72 offen offset:0
    v_mul_f32 v72, v72, v60
    v_mul_f32 v73, v73, v60
    v_mul_f32 v74, v74, v60
    v_mul_f32 v75, v75, v60
    s_waitcnt lgkmcnt(0)
    v_mfma_f32_32x32x16_bf16 v[112:127], a[60:63], v[252:255], v[112:127]
    v_mul_f32 v76, v76, v60
    v_mul_f32 v77, v77, v60
    v_mul_f32 v78, v78, v60
    v_mul_f32 v79, v79, v60
    v_cvt_pk_bf16_f32 v72, v72, v73
    v_cvt_pk_bf16_f32 v73, v74, v75
    v_cvt_pk_bf16_f32 v74, v76, v77
    v_cvt_pk_bf16_f32 v75, v78, v79
    buffer_store_dwordx4 v[72:75], v63, s[28:31], s72 offen offset:512
    v_mul_f32 v80, v80, v60
    v_mul_f32 v81, v81, v60
    v_mul_f32 v82, v82, v60
    v_mul_f32 v83, v83, v60
    v_mul_f32 v84, v84, v60
    v_mul_f32 v85, v85, v60
    v_mul_f32 v86, v86, v60
    v_mul_f32 v87, v87, v60
    v_cvt_pk_bf16_f32 v80, v80, v81
    v_cvt_pk_bf16_f32 v81, v82, v83
    v_cvt_pk_bf16_f32 v82, v84, v85
    v_cvt_pk_bf16_f32 v83, v86, v87
    s_mov_b32 s72, 3072
    buffer_store_dwordx4 v[80:83], v63, s[28:31], s72 offen offset:0
    v_mul_f32 v88, v88, v60
    v_mul_f32 v89, v89, v60
    v_mul_f32 v90, v90, v60
    v_mul_f32 v91, v91, v60
    v_mul_f32 v92, v92, v60
    v_mul_f32 v93, v93, v60
    v_mul_f32 v94, v94, v60
    v_mul_f32 v95, v95, v60
    v_cvt_pk_bf16_f32 v88, v88, v89
    v_cvt_pk_bf16_f32 v89, v90, v91
    v_cvt_pk_bf16_f32 v90, v92, v93
    v_cvt_pk_bf16_f32 v91, v94, v95
    buffer_store_dwordx4 v[88:91], v63, s[28:31], s72 offen offset:512
    v_pk_mul_f32 v[96:97], v[96:97], v[60:61]
    v_pk_mul_f32 v[98:99], v[98:99], v[60:61]
    v_pk_mul_f32 v[100:101], v[100:101], v[60:61]
    v_pk_mul_f32 v[102:103], v[102:103], v[60:61]
    v_cvt_pk_bf16_f32 v96, v96, v97
    v_cvt_pk_bf16_f32 v97, v98, v99
    v_cvt_pk_bf16_f32 v98, v100, v101
    v_cvt_pk_bf16_f32 v99, v102, v103
    s_mov_b32 s72, 6144
    buffer_store_dwordx4 v[96:99], v63, s[28:31], s72 offen offset:0
    v_pk_mul_f32 v[104:105], v[104:105], v[60:61]
    v_pk_mul_f32 v[106:107], v[106:107], v[60:61]
    v_pk_mul_f32 v[108:109], v[108:109], v[60:61]
    v_pk_mul_f32 v[110:111], v[110:111], v[60:61]
    v_cvt_pk_bf16_f32 v104, v104, v105
    v_cvt_pk_bf16_f32 v105, v106, v107
    v_cvt_pk_bf16_f32 v106, v108, v109
    v_cvt_pk_bf16_f32 v107, v110, v111
    buffer_store_dwordx4 v[104:107], v63, s[28:31], s72 offen offset:512
    v_pk_mul_f32 v[112:113], v[112:113], v[60:61]
    v_pk_mul_f32 v[114:115], v[114:115], v[60:61]
    v_pk_mul_f32 v[116:117], v[116:117], v[60:61]
    v_pk_mul_f32 v[118:119], v[118:119], v[60:61]
    v_cvt_pk_bf16_f32 v112, v112, v113
    v_cvt_pk_bf16_f32 v113, v114, v115
    v_cvt_pk_bf16_f32 v114, v116, v117
    v_cvt_pk_bf16_f32 v115, v118, v119
    s_mov_b32 s72, 9216
    buffer_store_dwordx4 v[112:115], v63, s[28:31], s72 offen offset:0
    v_pk_mul_f32 v[120:121], v[120:121], v[60:61]
    v_pk_mul_f32 v[122:123], v[122:123], v[60:61]
    v_pk_mul_f32 v[124:125], v[124:125], v[60:61]
    v_pk_mul_f32 v[126:127], v[126:127], v[60:61]
    v_cvt_pk_bf16_f32 v120, v120, v121
    v_cvt_pk_bf16_f32 v121, v122, v123
    v_cvt_pk_bf16_f32 v122, v124, v125
    v_cvt_pk_bf16_f32 v123, v126, v127
    buffer_store_dwordx4 v[120:123], v63, s[28:31], s72 offen offset:512
    s_endpgm
L_k1load_2:
    v_lshrrev_b32 v45, 4, v1
    v_and_b32 v46, 15, v1
    v_xor_b32 v47, v46, v45
    v_lshlrev_b32 v47, 4, v47
    v_lshl_add_u32 v224, v45, 8, v47
    v_xor_b32 v225, 64, v224
    v_xor_b32 v226, 128, v224
    v_xor_b32 v227, 192, v224
    v_lshlrev_b32 v47, 2, v45
    v_xor_b32 v47, v46, v47
    v_lshlrev_b32 v47, 4, v47
    v_lshl_add_u32 v228, v45, 8, v47
    s_mul_i32 s72, s3, 49152
    v_and_b32 v44, 31, v1
    v_lshlrev_b32 v44, 11, v44
    v_lshrrev_b32 v46, 5, v1
    v_lshl_add_u32 v44, v46, 7, v44
    v_add_u32 v229, s72, v44
    s_lshl_b32 s72, s3, 14
    v_lshlrev_b32 v44, 19, v45
    v_bfe_u32 v46, v1, 3, 1
    v_lshl_add_u32 v44, v46, 13, v44
    v_and_b32 v46, 7, v1
    v_lshl_add_u32 v44, v46, 7, v44
    v_add_u32 v230, s72, v44
    s_lshl_b32 s72, s17, 5
    s_add_u32 s72, s72, s18
    s_lshl_b32 s72, s72, 17
    s_lshl_b32 s73, s19, 10
    s_waitcnt lgkmcnt(0)
    s_mov_b32 s40, s4
    s_mov_b32 s41, s5
    s_mov_b32 s42, 1572864
    s_mov_b32 s43, 0x00020000
    s_add_u32 s44, s10, s73
    s_addc_u32 s45, s11, 0
    s_sub_u32 s46, 8388608, s73
    s_mov_b32 s47, 0x00020000
    s_add_u32 s32, s6, s72
    s_addc_u32 s33, s7, 0
    s_mov_b32 s34, 131072
    s_mov_b32 s35, 0x00020000
    s_add_u32 s36, s8, s72
    s_addc_u32 s37, s9, 0
    s_mov_b32 s38, 131072
    s_mov_b32 s39, 0x00020000
    s_barrier
    s_mov_b32 m0, 0
    s_mov_b32 s72, 0
    buffer_load_dwordx4 v224, s[32:35], s72 offen offset:0 nt lds
    buffer_load_dwordx4 v225, s[32:35], s72 offen offset:1024 nt lds
    buffer_load_dwordx4 v226, s[32:35], s72 offen offset:2048 nt lds
    buffer_load_dwordx4 v227, s[32:35], s72 offen offset:3072 nt lds
    s_mov_b32 m0, 4096
    s_mov_b32 s72, 4096
    buffer_load_dwordx4 v224, s[32:35], s72 offen offset:0 nt lds
    buffer_load_dwordx4 v225, s[32:35], s72 offen offset:1024 nt lds
    buffer_load_dwordx4 v226, s[32:35], s72 offen offset:2048 nt lds
    buffer_load_dwordx4 v227, s[32:35], s72 offen offset:3072 nt lds
    s_barrier
    s_mov_b32 m0, 8192
    s_mov_b32 s72, 8192
    buffer_load_dwordx4 v224, s[32:35], s72 offen offset:0 nt lds
    buffer_load_dwordx4 v225, s[32:35], s72 offen offset:1024 nt lds
    buffer_load_dwordx4 v226, s[32:35], s72 offen offset:2048 nt lds
    buffer_load_dwordx4 v227, s[32:35], s72 offen offset:3072 nt lds
    s_mov_b32 m0, 12288
    s_mov_b32 s72, 12288
    buffer_load_dwordx4 v224, s[32:35], s72 offen offset:0 nt lds
    buffer_load_dwordx4 v225, s[32:35], s72 offen offset:1024 nt lds
    buffer_load_dwordx4 v226, s[32:35], s72 offen offset:2048 nt lds
    buffer_load_dwordx4 v227, s[32:35], s72 offen offset:3072 nt lds
    s_barrier
    s_barrier
    s_mov_b32 m0, 16384
    s_mov_b32 s72, 16384
    buffer_load_dwordx4 v224, s[32:35], s72 offen offset:0 nt lds
    buffer_load_dwordx4 v225, s[32:35], s72 offen offset:1024 nt lds
    buffer_load_dwordx4 v226, s[32:35], s72 offen offset:2048 nt lds
    buffer_load_dwordx4 v227, s[32:35], s72 offen offset:3072 nt lds
    s_mov_b32 m0, 20480
    s_mov_b32 s72, 20480
    buffer_load_dwordx4 v224, s[32:35], s72 offen offset:0 nt lds
    buffer_load_dwordx4 v225, s[32:35], s72 offen offset:1024 nt lds
    buffer_load_dwordx4 v226, s[32:35], s72 offen offset:2048 nt lds
    buffer_load_dwordx4 v227, s[32:35], s72 offen offset:3072 nt lds
    s_barrier
    s_mov_b32 m0, 24576
    s_mov_b32 s72, 24576
    buffer_load_dwordx4 v224, s[32:35], s72 offen offset:0 nt lds
    buffer_load_dwordx4 v225, s[32:35], s72 offen offset:1024 nt lds
    buffer_load_dwordx4 v226, s[32:35], s72 offen offset:2048 nt lds
    buffer_load_dwordx4 v227, s[32:35], s72 offen offset:3072 nt lds
    s_mov_b32 m0, 28672
    s_mov_b32 s72, 28672
    buffer_load_dwordx4 v224, s[32:35], s72 offen offset:0 nt lds
    buffer_load_dwordx4 v225, s[32:35], s72 offen offset:1024 nt lds
    buffer_load_dwordx4 v226, s[32:35], s72 offen offset:2048 nt lds
    buffer_load_dwordx4 v227, s[32:35], s72 offen offset:3072 nt lds
    s_barrier
    s_barrier
    s_mov_b32 m0, 32768
    s_mov_b32 s72, 32768
    buffer_load_dwordx4 v224, s[32:35], s72 offen offset:0 nt lds
    buffer_load_dwordx4 v225, s[32:35], s72 offen offset:1024 nt lds
    buffer_load_dwordx4 v226, s[32:35], s72 offen offset:2048 nt lds
    buffer_load_dwordx4 v227, s[32:35], s72 offen offset:3072 nt lds
    s_mov_b32 m0, 36864
    s_mov_b32 s72, 36864
    buffer_load_dwordx4 v224, s[32:35], s72 offen offset:0 nt lds
    buffer_load_dwordx4 v225, s[32:35], s72 offen offset:1024 nt lds
    buffer_load_dwordx4 v226, s[32:35], s72 offen offset:2048 nt lds
    buffer_load_dwordx4 v227, s[32:35], s72 offen offset:3072 nt lds
    s_barrier
    s_mov_b32 m0, 40960
    s_mov_b32 s72, 40960
    buffer_load_dwordx4 v224, s[32:35], s72 offen offset:0 nt lds
    buffer_load_dwordx4 v225, s[32:35], s72 offen offset:1024 nt lds
    buffer_load_dwordx4 v226, s[32:35], s72 offen offset:2048 nt lds
    buffer_load_dwordx4 v227, s[32:35], s72 offen offset:3072 nt lds
    s_mov_b32 m0, 45056
    s_mov_b32 s72, 45056
    buffer_load_dwordx4 v224, s[32:35], s72 offen offset:0 nt lds
    buffer_load_dwordx4 v225, s[32:35], s72 offen offset:1024 nt lds
    buffer_load_dwordx4 v226, s[32:35], s72 offen offset:2048 nt lds
    buffer_load_dwordx4 v227, s[32:35], s72 offen offset:3072 nt lds
    s_barrier
    s_barrier
    s_mov_b32 m0, 49152
    s_mov_b32 s72, 49152
    buffer_load_dwordx4 v224, s[32:35], s72 offen offset:0 nt lds
    buffer_load_dwordx4 v225, s[32:35], s72 offen offset:1024 nt lds
    buffer_load_dwordx4 v226, s[32:35], s72 offen offset:2048 nt lds
    buffer_load_dwordx4 v227, s[32:35], s72 offen offset:3072 nt lds
    s_mov_b32 m0, 53248
    s_mov_b32 s72, 53248
    buffer_load_dwordx4 v224, s[32:35], s72 offen offset:0 nt lds
    buffer_load_dwordx4 v225, s[32:35], s72 offen offset:1024 nt lds
    buffer_load_dwordx4 v226, s[32:35], s72 offen offset:2048 nt lds
    buffer_load_dwordx4 v227, s[32:35], s72 offen offset:3072 nt lds
    s_barrier
    s_waitcnt vmcnt(55)
    s_mov_b32 m0, 57344
    s_mov_b32 s72, 57344
    buffer_load_dwordx4 v224, s[32:35], s72 offen offset:0 nt lds
    buffer_load_dwordx4 v225, s[32:35], s72 offen offset:1024 nt lds
    buffer_load_dwordx4 v226, s[32:35], s72 offen offset:2048 nt lds
    buffer_load_dwordx4 v227, s[32:35], s72 offen offset:3072 nt lds
    s_mov_b32 m0, 61440
    s_mov_b32 s72, 61440
    buffer_load_dwordx4 v224, s[32:35], s72 offen offset:0 nt lds
    buffer_load_dwordx4 v225, s[32:35], s72 offen offset:1024 nt lds
    buffer_load_dwordx4 v226, s[32:35], s72 offen offset:2048 nt lds
    s_waitcnt vmcnt(61)
    buffer_load_dwordx4 v227, s[32:35], s72 offen offset:3072 nt lds
    s_barrier
    s_waitcnt vmcnt(55)
    s_mov_b32 m0, 65536
    s_mov_b32 s72, 65536
    buffer_load_dwordx4 v224, s[32:35], s72 offen offset:0 nt lds
    buffer_load_dwordx4 v225, s[32:35], s72 offen offset:1024 nt lds
    buffer_load_dwordx4 v226, s[32:35], s72 offen offset:2048 nt lds
    buffer_load_dwordx4 v227, s[32:35], s72 offen offset:3072 nt lds
    s_mov_b32 m0, 69632
    s_mov_b32 s72, 69632
    buffer_load_dwordx4 v224, s[32:35], s72 offen offset:0 nt lds
    buffer_load_dwordx4 v225, s[32:35], s72 offen offset:1024 nt lds
    buffer_load_dwordx4 v226, s[32:35], s72 offen offset:2048 nt lds
    s_waitcnt vmcnt(61)
    buffer_load_dwordx4 v227, s[32:35], s72 offen offset:3072 nt lds
    s_barrier
    s_barrier
    s_barrier
    s_waitcnt vmcnt(55)
    s_mov_b32 m0, 73728
    s_mov_b32 s72, 73728
    buffer_load_dwordx4 v224, s[32:35], s72 offen offset:0 nt lds
    buffer_load_dwordx4 v225, s[32:35], s72 offen offset:1024 nt lds
    buffer_load_dwordx4 v226, s[32:35], s72 offen offset:2048 nt lds
    buffer_load_dwordx4 v227, s[32:35], s72 offen offset:3072 nt lds
    s_mov_b32 m0, 77824
    s_mov_b32 s72, 77824
    buffer_load_dwordx4 v224, s[32:35], s72 offen offset:0 nt lds
    buffer_load_dwordx4 v225, s[32:35], s72 offen offset:1024 nt lds
    buffer_load_dwordx4 v226, s[32:35], s72 offen offset:2048 nt lds
    s_waitcnt vmcnt(61)
    buffer_load_dwordx4 v227, s[32:35], s72 offen offset:3072 nt lds
    s_waitcnt vmcnt(55)
    s_mov_b32 m0, 81920
    s_mov_b32 s72, 81920
    buffer_load_dwordx4 v224, s[32:35], s72 offen offset:0 nt lds
    buffer_load_dwordx4 v225, s[32:35], s72 offen offset:1024 nt lds
    buffer_load_dwordx4 v226, s[32:35], s72 offen offset:2048 nt lds
    buffer_load_dwordx4 v227, s[32:35], s72 offen offset:3072 nt lds
    s_mov_b32 m0, 86016
    s_mov_b32 s72, 86016
    buffer_load_dwordx4 v224, s[32:35], s72 offen offset:0 nt lds
    buffer_load_dwordx4 v225, s[32:35], s72 offen offset:1024 nt lds
    buffer_load_dwordx4 v226, s[32:35], s72 offen offset:2048 nt lds
    s_waitcnt vmcnt(61)
    buffer_load_dwordx4 v227, s[32:35], s72 offen offset:3072 nt lds
    s_waitcnt vmcnt(55)
    s_mov_b32 m0, 90112
    s_mov_b32 s72, 90112
    buffer_load_dwordx4 v224, s[32:35], s72 offen offset:0 nt lds
    buffer_load_dwordx4 v225, s[32:35], s72 offen offset:1024 nt lds
    buffer_load_dwordx4 v226, s[32:35], s72 offen offset:2048 nt lds
    buffer_load_dwordx4 v227, s[32:35], s72 offen offset:3072 nt lds
    s_mov_b32 m0, 94208
    s_mov_b32 s72, 94208
    buffer_load_dwordx4 v224, s[32:35], s72 offen offset:0 nt lds
    buffer_load_dwordx4 v225, s[32:35], s72 offen offset:1024 nt lds
    buffer_load_dwordx4 v226, s[32:35], s72 offen offset:2048 nt lds
    s_waitcnt vmcnt(61)
    buffer_load_dwordx4 v227, s[32:35], s72 offen offset:3072 nt lds
    s_waitcnt vmcnt(55)
    s_mov_b32 m0, 98304
    s_mov_b32 s72, 98304
    buffer_load_dwordx4 v224, s[32:35], s72 offen offset:0 nt lds
    buffer_load_dwordx4 v225, s[32:35], s72 offen offset:1024 nt lds
    buffer_load_dwordx4 v226, s[32:35], s72 offen offset:2048 nt lds
    buffer_load_dwordx4 v227, s[32:35], s72 offen offset:3072 nt lds
    s_mov_b32 m0, 102400
    s_mov_b32 s72, 102400
    buffer_load_dwordx4 v224, s[32:35], s72 offen offset:0 nt lds
    buffer_load_dwordx4 v225, s[32:35], s72 offen offset:1024 nt lds
    buffer_load_dwordx4 v226, s[32:35], s72 offen offset:2048 nt lds
    s_waitcnt vmcnt(61)
    buffer_load_dwordx4 v227, s[32:35], s72 offen offset:3072 nt lds
    s_barrier
    s_waitcnt vmcnt(55)
    s_mov_b32 m0, 106496
    s_mov_b32 s72, 106496
    buffer_load_dwordx4 v224, s[32:35], s72 offen offset:0 nt lds
    buffer_load_dwordx4 v225, s[32:35], s72 offen offset:1024 nt lds
    buffer_load_dwordx4 v226, s[32:35], s72 offen offset:2048 nt lds
    buffer_load_dwordx4 v227, s[32:35], s72 offen offset:3072 nt lds
    s_mov_b32 m0, 110592
    s_mov_b32 s72, 110592
    buffer_load_dwordx4 v224, s[32:35], s72 offen offset:0 nt lds
    buffer_load_dwordx4 v225, s[32:35], s72 offen offset:1024 nt lds
    buffer_load_dwordx4 v226, s[32:35], s72 offen offset:2048 nt lds
    s_waitcnt vmcnt(61)
    buffer_load_dwordx4 v227, s[32:35], s72 offen offset:3072 nt lds
    s_waitcnt vmcnt(55)
    s_mov_b32 m0, 114688
    s_mov_b32 s72, 114688
    buffer_load_dwordx4 v224, s[32:35], s72 offen offset:0 nt lds
    buffer_load_dwordx4 v225, s[32:35], s72 offen offset:1024 nt lds
    buffer_load_dwordx4 v226, s[32:35], s72 offen offset:2048 nt lds
    buffer_load_dwordx4 v227, s[32:35], s72 offen offset:3072 nt lds
    s_mov_b32 m0, 118784
    s_mov_b32 s72, 118784
    buffer_load_dwordx4 v224, s[32:35], s72 offen offset:0 nt lds
    buffer_load_dwordx4 v225, s[32:35], s72 offen offset:1024 nt lds
    buffer_load_dwordx4 v226, s[32:35], s72 offen offset:2048 nt lds
    s_waitcnt vmcnt(61)
    buffer_load_dwordx4 v227, s[32:35], s72 offen offset:3072 nt lds
    s_waitcnt vmcnt(55)
    s_mov_b32 m0, 122880
    s_mov_b32 s72, 122880
    buffer_load_dwordx4 v224, s[32:35], s72 offen offset:0 nt lds
    buffer_load_dwordx4 v225, s[32:35], s72 offen offset:1024 nt lds
    buffer_load_dwordx4 v226, s[32:35], s72 offen offset:2048 nt lds
    buffer_load_dwordx4 v227, s[32:35], s72 offen offset:3072 nt lds
    s_mov_b32 m0, 126976
    s_mov_b32 s72, 126976
    buffer_load_dwordx4 v224, s[32:35], s72 offen offset:0 nt lds
    buffer_load_dwordx4 v225, s[32:35], s72 offen offset:1024 nt lds
    buffer_load_dwordx4 v226, s[32:35], s72 offen offset:2048 nt lds
    s_waitcnt vmcnt(61)
    buffer_load_dwordx4 v227, s[32:35], s72 offen offset:3072 nt lds
    s_barrier
    s_barrier
    s_barrier
    s_barrier
    s_waitcnt vmcnt(56)
    s_waitcnt vmcnt(48)
    s_mov_b32 m0, 131072
    s_mov_b32 s72, 0
    buffer_load_dwordx4 v228, s[36:39], s72 offen offset:0 nt lds
    buffer_load_dwordx4 v228, s[36:39], s72 offen offset:1024 nt lds
    buffer_load_dwordx4 v228, s[36:39], s72 offen offset:2048 nt lds
    buffer_load_dwordx4 v228, s[36:39], s72 offen offset:3072 nt lds
    s_mov_b32 m0, 135168
    s_mov_b32 s72, 4096
    buffer_load_dwordx4 v228, s[36:39], s72 offen offset:0 nt lds
    buffer_load_dwordx4 v228, s[36:39], s72 offen offset:1024 nt lds
    buffer_load_dwordx4 v228, s[36:39], s72 offen offset:2048 nt lds
    buffer_load_dwordx4 v228, s[36:39], s72 offen offset:3072 nt lds
    s_barrier
    s_waitcnt vmcnt(48)
    s_mov_b32 m0, 139264
    s_mov_b32 s72, 8192
    buffer_load_dwordx4 v228, s[36:39], s72 offen offset:0 nt lds
    buffer_load_dwordx4 v228, s[36:39], s72 offen offset:1024 nt lds
    buffer_load_dwordx4 v228, s[36:39], s72 offen offset:2048 nt lds
    buffer_load_dwordx4 v228, s[36:39], s72 offen offset:3072 nt lds
    s_mov_b32 m0, 143360
    s_mov_b32 s72, 12288
    buffer_load_dwordx4 v228, s[36:39], s72 offen offset:0 nt lds
    buffer_load_dwordx4 v228, s[36:39], s72 offen offset:1024 nt lds
    buffer_load_dwordx4 v228, s[36:39], s72 offen offset:2048 nt lds
    buffer_load_dwordx4 v228, s[36:39], s72 offen offset:3072 nt lds
    s_waitcnt vmcnt(48)
    s_mov_b32 m0, 147456
    s_mov_b32 s72, 16384
    buffer_load_dwordx4 v228, s[36:39], s72 offen offset:0 nt lds
    buffer_load_dwordx4 v228, s[36:39], s72 offen offset:1024 nt lds
    buffer_load_dwordx4 v228, s[36:39], s72 offen offset:2048 nt lds
    buffer_load_dwordx4 v228, s[36:39], s72 offen offset:3072 nt lds
    s_mov_b32 m0, 151552
    s_mov_b32 s72, 20480
    buffer_load_dwordx4 v228, s[36:39], s72 offen offset:0 nt lds
    buffer_load_dwordx4 v228, s[36:39], s72 offen offset:1024 nt lds
    buffer_load_dwordx4 v228, s[36:39], s72 offen offset:2048 nt lds
    buffer_load_dwordx4 v228, s[36:39], s72 offen offset:3072 nt lds
    s_barrier
    s_waitcnt vmcnt(48)
    s_mov_b32 m0, 155648
    s_mov_b32 s72, 24576
    buffer_load_dwordx4 v228, s[36:39], s72 offen offset:0 nt lds
    buffer_load_dwordx4 v228, s[36:39], s72 offen offset:1024 nt lds
    buffer_load_dwordx4 v228, s[36:39], s72 offen offset:2048 nt lds
    buffer_load_dwordx4 v228, s[36:39], s72 offen offset:3072 nt lds
    s_mov_b32 m0, 159744
    s_mov_b32 s72, 28672
    buffer_load_dwordx4 v228, s[36:39], s72 offen offset:0 nt lds
    buffer_load_dwordx4 v228, s[36:39], s72 offen offset:1024 nt lds
    buffer_load_dwordx4 v228, s[36:39], s72 offen offset:2048 nt lds
    buffer_load_dwordx4 v228, s[36:39], s72 offen offset:3072 nt lds
    s_waitcnt vmcnt(48)
    s_mov_b32 m0, 0
    s_mov_b32 s72, 32768
    buffer_load_dwordx4 v228, s[36:39], s72 offen offset:0 nt lds
    buffer_load_dwordx4 v228, s[36:39], s72 offen offset:1024 nt lds
    buffer_load_dwordx4 v228, s[36:39], s72 offen offset:2048 nt lds
    buffer_load_dwordx4 v228, s[36:39], s72 offen offset:3072 nt lds
    s_mov_b32 m0, 4096
    s_mov_b32 s72, 36864
    buffer_load_dwordx4 v228, s[36:39], s72 offen offset:0 nt lds
    buffer_load_dwordx4 v228, s[36:39], s72 offen offset:1024 nt lds
    buffer_load_dwordx4 v228, s[36:39], s72 offen offset:2048 nt lds
    buffer_load_dwordx4 v228, s[36:39], s72 offen offset:3072 nt lds
    s_barrier
    s_waitcnt vmcnt(48)
    s_mov_b32 m0, 8192
    s_mov_b32 s72, 40960
    buffer_load_dwordx4 v228, s[36:39], s72 offen offset:0 nt lds
    buffer_load_dwordx4 v228, s[36:39], s72 offen offset:1024 nt lds
    buffer_load_dwordx4 v228, s[36:39], s72 offen offset:2048 nt lds
    buffer_load_dwordx4 v228, s[36:39], s72 offen offset:3072 nt lds
    s_mov_b32 m0, 12288
    s_mov_b32 s72, 45056
    buffer_load_dwordx4 v228, s[36:39], s72 offen offset:0 nt lds
    buffer_load_dwordx4 v228, s[36:39], s72 offen offset:1024 nt lds
    buffer_load_dwordx4 v228, s[36:39], s72 offen offset:2048 nt lds
    buffer_load_dwordx4 v228, s[36:39], s72 offen offset:3072 nt lds
    s_waitcnt vmcnt(48)
    s_mov_b32 m0, 16384
    s_mov_b32 s72, 49152
    buffer_load_dwordx4 v228, s[36:39], s72 offen offset:0 nt lds
    buffer_load_dwordx4 v228, s[36:39], s72 offen offset:1024 nt lds
    buffer_load_dwordx4 v228, s[36:39], s72 offen offset:2048 nt lds
    buffer_load_dwordx4 v228, s[36:39], s72 offen offset:3072 nt lds
    s_mov_b32 m0, 20480
    s_mov_b32 s72, 53248
    buffer_load_dwordx4 v228, s[36:39], s72 offen offset:0 nt lds
    buffer_load_dwordx4 v228, s[36:39], s72 offen offset:1024 nt lds
    buffer_load_dwordx4 v228, s[36:39], s72 offen offset:2048 nt lds
    buffer_load_dwordx4 v228, s[36:39], s72 offen offset:3072 nt lds
    s_barrier
    s_waitcnt vmcnt(48)
    s_mov_b32 m0, 24576
    s_mov_b32 s72, 57344
    buffer_load_dwordx4 v228, s[36:39], s72 offen offset:0 nt lds
    buffer_load_dwordx4 v228, s[36:39], s72 offen offset:1024 nt lds
    buffer_load_dwordx4 v228, s[36:39], s72 offen offset:2048 nt lds
    buffer_load_dwordx4 v228, s[36:39], s72 offen offset:3072 nt lds
    s_mov_b32 m0, 28672
    s_mov_b32 s72, 61440
    buffer_load_dwordx4 v228, s[36:39], s72 offen offset:0 nt lds
    buffer_load_dwordx4 v228, s[36:39], s72 offen offset:1024 nt lds
    buffer_load_dwordx4 v228, s[36:39], s72 offen offset:2048 nt lds
    buffer_load_dwordx4 v228, s[36:39], s72 offen offset:3072 nt lds
    s_waitcnt vmcnt(48)
    s_mov_b32 m0, 32768
    s_mov_b32 s72, 65536
    buffer_load_dwordx4 v228, s[36:39], s72 offen offset:0 nt lds
    buffer_load_dwordx4 v228, s[36:39], s72 offen offset:1024 nt lds
    buffer_load_dwordx4 v228, s[36:39], s72 offen offset:2048 nt lds
    buffer_load_dwordx4 v228, s[36:39], s72 offen offset:3072 nt lds
    s_mov_b32 m0, 36864
    s_mov_b32 s72, 69632
    buffer_load_dwordx4 v228, s[36:39], s72 offen offset:0 nt lds
    buffer_load_dwordx4 v228, s[36:39], s72 offen offset:1024 nt lds
    buffer_load_dwordx4 v228, s[36:39], s72 offen offset:2048 nt lds
    buffer_load_dwordx4 v228, s[36:39], s72 offen offset:3072 nt lds
    s_barrier
    s_waitcnt vmcnt(48)
    s_mov_b32 m0, 40960
    s_mov_b32 s72, 73728
    buffer_load_dwordx4 v228, s[36:39], s72 offen offset:0 nt lds
    buffer_load_dwordx4 v228, s[36:39], s72 offen offset:1024 nt lds
    buffer_load_dwordx4 v228, s[36:39], s72 offen offset:2048 nt lds
    buffer_load_dwordx4 v228, s[36:39], s72 offen offset:3072 nt lds
    s_mov_b32 m0, 45056
    s_mov_b32 s72, 77824
    buffer_load_dwordx4 v228, s[36:39], s72 offen offset:0 nt lds
    buffer_load_dwordx4 v228, s[36:39], s72 offen offset:1024 nt lds
    buffer_load_dwordx4 v228, s[36:39], s72 offen offset:2048 nt lds
    buffer_load_dwordx4 v228, s[36:39], s72 offen offset:3072 nt lds
    s_waitcnt vmcnt(48)
    s_mov_b32 m0, 49152
    s_mov_b32 s72, 81920
    buffer_load_dwordx4 v228, s[36:39], s72 offen offset:0 nt lds
    buffer_load_dwordx4 v228, s[36:39], s72 offen offset:1024 nt lds
    buffer_load_dwordx4 v228, s[36:39], s72 offen offset:2048 nt lds
    buffer_load_dwordx4 v228, s[36:39], s72 offen offset:3072 nt lds
    s_mov_b32 m0, 53248
    s_mov_b32 s72, 86016
    buffer_load_dwordx4 v228, s[36:39], s72 offen offset:0 nt lds
    buffer_load_dwordx4 v228, s[36:39], s72 offen offset:1024 nt lds
    buffer_load_dwordx4 v228, s[36:39], s72 offen offset:2048 nt lds
    buffer_load_dwordx4 v228, s[36:39], s72 offen offset:3072 nt lds
    s_barrier
    s_waitcnt vmcnt(48)
    s_mov_b32 m0, 57344
    s_mov_b32 s72, 90112
    buffer_load_dwordx4 v228, s[36:39], s72 offen offset:0 nt lds
    buffer_load_dwordx4 v228, s[36:39], s72 offen offset:1024 nt lds
    buffer_load_dwordx4 v228, s[36:39], s72 offen offset:2048 nt lds
    buffer_load_dwordx4 v228, s[36:39], s72 offen offset:3072 nt lds
    s_mov_b32 m0, 61440
    s_mov_b32 s72, 94208
    buffer_load_dwordx4 v228, s[36:39], s72 offen offset:0 nt lds
    buffer_load_dwordx4 v228, s[36:39], s72 offen offset:1024 nt lds
    buffer_load_dwordx4 v228, s[36:39], s72 offen offset:2048 nt lds
    buffer_load_dwordx4 v228, s[36:39], s72 offen offset:3072 nt lds
    s_waitcnt vmcnt(48)
    s_mov_b32 m0, 65536
    s_mov_b32 s72, 98304
    buffer_load_dwordx4 v228, s[36:39], s72 offen offset:0 nt lds
    buffer_load_dwordx4 v228, s[36:39], s72 offen offset:1024 nt lds
    buffer_load_dwordx4 v228, s[36:39], s72 offen offset:2048 nt lds
    buffer_load_dwordx4 v228, s[36:39], s72 offen offset:3072 nt lds
    s_mov_b32 m0, 69632
    s_mov_b32 s72, 102400
    buffer_load_dwordx4 v228, s[36:39], s72 offen offset:0 nt lds
    buffer_load_dwordx4 v228, s[36:39], s72 offen offset:1024 nt lds
    buffer_load_dwordx4 v228, s[36:39], s72 offen offset:2048 nt lds
    buffer_load_dwordx4 v228, s[36:39], s72 offen offset:3072 nt lds
    s_barrier
    s_waitcnt vmcnt(48)
    s_mov_b32 m0, 73728
    s_mov_b32 s72, 106496
    buffer_load_dwordx4 v228, s[36:39], s72 offen offset:0 nt lds
    buffer_load_dwordx4 v228, s[36:39], s72 offen offset:1024 nt lds
    buffer_load_dwordx4 v228, s[36:39], s72 offen offset:2048 nt lds
    buffer_load_dwordx4 v228, s[36:39], s72 offen offset:3072 nt lds
    s_mov_b32 m0, 77824
    s_mov_b32 s72, 110592
    buffer_load_dwordx4 v228, s[36:39], s72 offen offset:0 nt lds
    buffer_load_dwordx4 v228, s[36:39], s72 offen offset:1024 nt lds
    buffer_load_dwordx4 v228, s[36:39], s72 offen offset:2048 nt lds
    buffer_load_dwordx4 v228, s[36:39], s72 offen offset:3072 nt lds
    s_waitcnt vmcnt(48)
    s_mov_b32 m0, 81920
    s_mov_b32 s72, 114688
    buffer_load_dwordx4 v228, s[36:39], s72 offen offset:0 nt lds
    buffer_load_dwordx4 v228, s[36:39], s72 offen offset:1024 nt lds
    buffer_load_dwordx4 v228, s[36:39], s72 offen offset:2048 nt lds
    buffer_load_dwordx4 v228, s[36:39], s72 offen offset:3072 nt lds
    s_mov_b32 m0, 86016
    s_mov_b32 s72, 118784
    buffer_load_dwordx4 v228, s[36:39], s72 offen offset:0 nt lds
    buffer_load_dwordx4 v228, s[36:39], s72 offen offset:1024 nt lds
    buffer_load_dwordx4 v228, s[36:39], s72 offen offset:2048 nt lds
    buffer_load_dwordx4 v228, s[36:39], s72 offen offset:3072 nt lds
    s_barrier
    s_waitcnt vmcnt(48)
    s_mov_b32 m0, 90112
    s_mov_b32 s72, 122880
    buffer_load_dwordx4 v228, s[36:39], s72 offen offset:0 nt lds
    buffer_load_dwordx4 v228, s[36:39], s72 offen offset:1024 nt lds
    buffer_load_dwordx4 v228, s[36:39], s72 offen offset:2048 nt lds
    buffer_load_dwordx4 v228, s[36:39], s72 offen offset:3072 nt lds
    s_mov_b32 m0, 94208
    s_mov_b32 s72, 126976
    buffer_load_dwordx4 v228, s[36:39], s72 offen offset:0 nt lds
    buffer_load_dwordx4 v228, s[36:39], s72 offen offset:1024 nt lds
    buffer_load_dwordx4 v228, s[36:39], s72 offen offset:2048 nt lds
    buffer_load_dwordx4 v228, s[36:39], s72 offen offset:3072 nt lds
    s_waitcnt vmcnt(48)
    s_barrier
    s_waitcnt vmcnt(40)
    s_waitcnt vmcnt(32)
    s_barrier
    s_load_dwordx2 s[4:5], s[0:1], 32
    v_lshrrev_b32 v44, 2, v1
    v_lshlrev_b32 v44, 11, v44
    v_and_b32 v45, 3, v1
    v_lshl_add_u32 v44, v45, 7, v44
    s_lshr_b32 s72, s19, 1
    s_lshl_b32 s72, s72, 9
    s_lshl_b32 s73, s3, 18
    s_add_u32 s72, s72, s73
    s_waitcnt lgkmcnt(0)
    s_add_u32 s44, s4, s72
    s_addc_u32 s45, s5, 0
    s_sub_u32 s46, 8388608, s72
    s_mov_b32 s47, 0x00020000
    s_mov_b32 s72, 0
    buffer_load_dword v232, v44, s[44:47], s72 offen
    s_mov_b32 s72, 32768
    buffer_load_dword v233, v44, s[44:47], s72 offen
    s_mov_b32 s72, 65536
    buffer_load_dword v234, v44, s[44:47], s72 offen
    s_mov_b32 s72, 98304
    buffer_load_dword v235, v44, s[44:47], s72 offen
    s_mov_b32 s72, 131072
    buffer_load_dword v236, v44, s[44:47], s72 offen
    s_mov_b32 s72, 163840
    buffer_load_dword v237, v44, s[44:47], s72 offen
    s_mov_b32 s72, 196608
    buffer_load_dword v238, v44, s[44:47], s72 offen
    s_mov_b32 s72, 229376
    buffer_load_dword v239, v44, s[44:47], s72 offen
    s_waitcnt vmcnt(32)
    s_waitcnt vmcnt(24)
    s_barrier
    s_waitcnt vmcnt(16)
    s_waitcnt vmcnt(8)
    s_barrier
    s_waitcnt vmcnt(0)
L_k1end_1:
    s_endpgm
.globl oproj_kernel
.p2align 8
.type oproj_kernel,@function
oproj_kernel:
    s_cmp_ge_u32 s2, 256
    s_cbranch_scc1 L_k2end_1
    s_load_dwordx4 s[4:7], s[0:1], 32
    s_load_dwordx2 s[8:9], s[0:1], 56
    v_and_b32 v1, 63, v0
    v_lshrrev_b32 v12, 6, v0
    s_and_b32 s3, s2, 7
    s_lshr_b32 s36, s2, 3
    v_readfirstlane_b32 s24, v12
    s_and_b32 s29, s3, 1
    s_lshl_b32 s29, s29, 3
    s_and_b32 s37, s36, 7
    s_add_u32 s29, s29, s37
    s_lshr_b32 s30, s3, 1
    s_lshl_b32 s30, s30, 2
    s_lshr_b32 s37, s36, 3
    s_add_u32 s30, s30, s37
    v_lshrrev_b32 v12, 3, v1
    v_lshlrev_b32 v12, 11, v12
    v_and_b32 v13, 1, v1
    v_lshl_add_u32 v12, v13, 4, v12
    v_bfe_u32 v13, v1, 1, 2
    v_bfe_u32 v14, v1, 4, 1
    v_xor_b32 v13, v13, v14
    v_lshl_add_u32 v2, v13, 5, v12
    v_xor_b32 v14, 2, v13
    v_lshl_add_u32 v3, v14, 5, v12
    v_add_u32 v3, 15360, v3
    v_lshl_add_u32 v4, v13, 5, v12
    v_add_u32 v4, 30720, v4
    v_xor_b32 v14, 2, v13
    v_lshl_add_u32 v5, v14, 5, v12
    v_add_u32 v5, 46080, v5
    v_lshlrev_b32 v6, 4, v1
    s_mul_i32 s25, s24, 32768
    v_lshrrev_b32 v12, 4, v1
    v_bfe_u32 v13, v1, 2, 2
    v_lshl_add_u32 v14, v12, 3, v13
    v_lshlrev_b32 v14, 7, v14
    v_and_b32 v12, 1, v12
    v_lshlrev_b32 v12, 1, v12
    v_bfe_u32 v13, v1, 3, 1
    v_or_b32 v12, v12, v13
    v_and_b32 v13, 3, v1
    v_lshl_add_u32 v14, v13, 3, v14
    v_add_u32 v14, s25, v14
    v_xor_b32 v13, 0, v12
    v_lshl_add_u32 v8, v13, 5, v14
    v_xor_b32 v13, 1, v12
    v_lshl_add_u32 v9, v13, 5, v14
    v_xor_b32 v13, 2, v12
    v_lshl_add_u32 v10, v13, 5, v14
    v_xor_b32 v13, 3, v12
    v_lshl_add_u32 v11, v13, 5, v14
    s_waitcnt lgkmcnt(0)
    s_lshl_b32 s36, s24, 21
    s_lshl_b32 s37, s30, 7
    s_add_u32 s36, s36, s37
    s_add_u32 s12, s4, s36
    s_addc_u32 s13, s5, 0
    s_sub_u32 s14, 8388608, s36
    s_mov_b32 s15, 0x00020000
    s_lshl_b32 s36, s29, 7
    s_lshl_b32 s37, s24, 5
    s_add_u32 s36, s36, s37
    s_mul_i32 s36, s36, 3072
    s_add_u32 s16, s8, s36
    s_addc_u32 s17, s9, 0
    s_mov_b32 s18, 98304
    s_mov_b32 s19, 0x00020000
    s_mov_b32 s20, s6
    s_mov_b32 s21, s7
    s_mov_b32 s22, 1572864
    s_mov_b32 s23, 0x00020000
    s_lshr_b32 s36, s2, 6
    s_and_b32 s36, s36, 0
    s_mul_i32 s36, s36, 0
    s_lshr_b32 s37, s2, 3
    s_and_b32 s37, s37, 7
    s_mul_i32 s37, s37, 4
    s_add_u32 s36, s36, s37
    s_mul_i32 s37, s24, 1
    s_add_u32 s36, s36, s37
    s_and_b32 s36, s36, 31
    s_lshl_b32 s26, s36, 16
    s_mul_i32 s27, s36, 3072
    s_add_u32 m0, s25, 0
    s_nop 0
    buffer_load_dwordx4 v2, s[12:15], s26 offen offset:0 lds
    buffer_load_dwordx4 v3, s[12:15], s26 offen offset:1024 lds
    buffer_load_dwordx4 v4, s[12:15], s26 offen offset:2048 lds
    buffer_load_dwordx4 v5, s[12:15], s26 offen offset:3072 lds
    s_add_u32 s26, s26, 65536
    s_and_b32 s26, s26, 2097151
    buffer_load_dwordx4 v[96:99], v6, s[16:19], s27 offen offset:0
    buffer_load_dwordx4 v[100:103], v6, s[16:19], s27 offen offset:1024
    buffer_load_dwordx4 v[104:107], v6, s[16:19], s27 offen offset:2048
    s_add_u32 s27, s27, 3072
    s_cmp_eq_u32 s27, 98304
    s_cselect_b32 s27, 0, s27
    s_add_u32 m0, s25, 4096
    s_nop 0
    buffer_load_dwordx4 v2, s[12:15], s26 offen offset:0 lds
    buffer_load_dwordx4 v3, s[12:15], s26 offen offset:1024 lds
    buffer_load_dwordx4 v4, s[12:15], s26 offen offset:2048 lds
    buffer_load_dwordx4 v5, s[12:15], s26 offen offset:3072 lds
    s_add_u32 s26, s26, 65536
    s_and_b32 s26, s26, 2097151
    buffer_load_dwordx4 v[108:111], v6, s[16:19], s27 offen offset:0
    buffer_load_dwordx4 v[112:115], v6, s[16:19], s27 offen offset:1024
    buffer_load_dwordx4 v[116:119], v6, s[16:19], s27 offen offset:2048
    s_add_u32 s27, s27, 3072
    s_cmp_eq_u32 s27, 98304
    s_cselect_b32 s27, 0, s27
    s_add_u32 m0, s25, 8192
    s_nop 0
    buffer_load_dwordx4 v2, s[12:15], s26 offen offset:0 lds
    buffer_load_dwordx4 v3, s[12:15], s26 offen offset:1024 lds
    buffer_load_dwordx4 v4, s[12:15], s26 offen offset:2048 lds
    buffer_load_dwordx4 v5, s[12:15], s26 offen offset:3072 lds
    s_add_u32 s26, s26, 65536
    s_and_b32 s26, s26, 2097151
    buffer_load_dwordx4 v[120:123], v6, s[16:19], s27 offen offset:0
    buffer_load_dwordx4 v[124:127], v6, s[16:19], s27 offen offset:1024
    buffer_load_dwordx4 v[128:131], v6, s[16:19], s27 offen offset:2048
    s_add_u32 s27, s27, 3072
    s_cmp_eq_u32 s27, 98304
    s_cselect_b32 s27, 0, s27
    s_add_u32 m0, s25, 12288
    s_nop 0
    buffer_load_dwordx4 v2, s[12:15], s26 offen offset:0 lds
    buffer_load_dwordx4 v3, s[12:15], s26 offen offset:1024 lds
    buffer_load_dwordx4 v4, s[12:15], s26 offen offset:2048 lds
    buffer_load_dwordx4 v5, s[12:15], s26 offen offset:3072 lds
    s_add_u32 s26, s26, 65536
    s_and_b32 s26, s26, 2097151
    buffer_load_dwordx4 v[132:135], v6, s[16:19], s27 offen offset:0
    buffer_load_dwordx4 v[136:139], v6, s[16:19], s27 offen offset:1024
    buffer_load_dwordx4 v[140:143], v6, s[16:19], s27 offen offset:2048
    s_add_u32 s27, s27, 3072
    s_cmp_eq_u32 s27, 98304
    s_cselect_b32 s27, 0, s27
    s_add_u32 m0, s25, 16384
    s_nop 0
    buffer_load_dwordx4 v2, s[12:15], s26 offen offset:0 lds
    buffer_load_dwordx4 v3, s[12:15], s26 offen offset:1024 lds
    buffer_load_dwordx4 v4, s[12:15], s26 offen offset:2048 lds
    buffer_load_dwordx4 v5, s[12:15], s26 offen offset:3072 lds
    s_add_u32 s26, s26, 65536
    s_and_b32 s26, s26, 2097151
    buffer_load_dwordx4 v[144:147], v6, s[16:19], s27 offen offset:0
    buffer_load_dwordx4 v[148:151], v6, s[16:19], s27 offen offset:1024
    buffer_load_dwordx4 v[152:155], v6, s[16:19], s27 offen offset:2048
    s_add_u32 s27, s27, 3072
    s_cmp_eq_u32 s27, 98304
    s_cselect_b32 s27, 0, s27
    s_add_u32 m0, s25, 20480
    s_nop 0
    buffer_load_dwordx4 v2, s[12:15], s26 offen offset:0 lds
    buffer_load_dwordx4 v3, s[12:15], s26 offen offset:1024 lds
    buffer_load_dwordx4 v4, s[12:15], s26 offen offset:2048 lds
    buffer_load_dwordx4 v5, s[12:15], s26 offen offset:3072 lds
    s_add_u32 s26, s26, 65536
    s_and_b32 s26, s26, 2097151
    buffer_load_dwordx4 v[156:159], v6, s[16:19], s27 offen offset:0
    buffer_load_dwordx4 v[160:163], v6, s[16:19], s27 offen offset:1024
    buffer_load_dwordx4 v[164:167], v6, s[16:19], s27 offen offset:2048
    s_add_u32 s27, s27, 3072
    s_cmp_eq_u32 s27, 98304
    s_cselect_b32 s27, 0, s27
    s_add_u32 m0, s25, 24576
    s_nop 0
    buffer_load_dwordx4 v2, s[12:15], s26 offen offset:0 lds
    buffer_load_dwordx4 v3, s[12:15], s26 offen offset:1024 lds
    buffer_load_dwordx4 v4, s[12:15], s26 offen offset:2048 lds
    buffer_load_dwordx4 v5, s[12:15], s26 offen offset:3072 lds
    s_add_u32 s26, s26, 65536
    s_and_b32 s26, s26, 2097151
    buffer_load_dwordx4 v[168:171], v6, s[16:19], s27 offen offset:0
    buffer_load_dwordx4 v[172:175], v6, s[16:19], s27 offen offset:1024
    buffer_load_dwordx4 v[176:179], v6, s[16:19], s27 offen offset:2048
    s_add_u32 s27, s27, 3072
    s_cmp_eq_u32 s27, 98304
    s_cselect_b32 s27, 0, s27
    s_add_u32 m0, s25, 28672
    s_nop 0
    buffer_load_dwordx4 v2, s[12:15], s26 offen offset:0 lds
    buffer_load_dwordx4 v3, s[12:15], s26 offen offset:1024 lds
    buffer_load_dwordx4 v4, s[12:15], s26 offen offset:2048 lds
    buffer_load_dwordx4 v5, s[12:15], s26 offen offset:3072 lds
    s_add_u32 s26, s26, 65536
    s_and_b32 s26, s26, 2097151
    buffer_load_dwordx4 v[180:183], v6, s[16:19], s27 offen offset:0
    buffer_load_dwordx4 v[184:187], v6, s[16:19], s27 offen offset:1024
    buffer_load_dwordx4 v[188:191], v6, s[16:19], s27 offen offset:2048
    s_add_u32 s27, s27, 3072
    s_cmp_eq_u32 s27, 98304
    s_cselect_b32 s27, 0, s27
    s_waitcnt vmcnt(49)
    ds_read_b64_tr_b16 v[16:17], v8 offset:0
    ds_read_b64_tr_b16 v[18:19], v8 offset:512
    ds_read_b64_tr_b16 v[20:21], v9 offset:0
    ds_read_b64_tr_b16 v[22:23], v9 offset:512
    ds_read_b64_tr_b16 v[24:25], v10 offset:0
    ds_read_b64_tr_b16 v[26:27], v10 offset:512
    ds_read_b64_tr_b16 v[28:29], v11 offset:0
    ds_read_b64_tr_b16 v[30:31], v11 offset:512
    v_mov_b32 v48, 0
    v_mov_b32 v49, 0
    v_mov_b32 v50, 0
    v_mov_b32 v51, 0
    v_mov_b32 v52, 0
    v_mov_b32 v53, 0
    v_mov_b32 v54, 0
    v_mov_b32 v55, 0
    v_mov_b32 v56, 0
    v_mov_b32 v57, 0
    v_mov_b32 v58, 0
    v_mov_b32 v59, 0
    v_mov_b32 v60, 0
    v_mov_b32 v61, 0
    v_mov_b32 v62, 0
    v_mov_b32 v63, 0
    v_mov_b32 v64, 0
    v_mov_b32 v65, 0
    v_mov_b32 v66, 0
    v_mov_b32 v67, 0
    v_mov_b32 v68, 0
    v_mov_b32 v69, 0
    v_mov_b32 v70, 0
    v_mov_b32 v71, 0
    v_mov_b32 v72, 0
    v_mov_b32 v73, 0
    v_mov_b32 v74, 0
    v_mov_b32 v75, 0
    v_mov_b32 v76, 0
    v_mov_b32 v77, 0
    v_mov_b32 v78, 0
    v_mov_b32 v79, 0
    v_mov_b32 v80, 0
    v_mov_b32 v81, 0
    v_mov_b32 v82, 0
    v_mov_b32 v83, 0
    v_mov_b32 v84, 0
    v_mov_b32 v85, 0
    v_mov_b32 v86, 0
    v_mov_b32 v87, 0
    v_mov_b32 v88, 0
    v_mov_b32 v89, 0
    v_mov_b32 v90, 0
    v_mov_b32 v91, 0
    v_mov_b32 v92, 0
    v_mov_b32 v93, 0
    v_mov_b32 v94, 0
    v_mov_b32 v95, 0
    s_mov_b32 s28, 3
L_k2loop_2:
    s_waitcnt vmcnt(42)
    ds_read_b64_tr_b16 v[32:33], v8 offset:4096
    ds_read_b64_tr_b16 v[34:35], v8 offset:4608
    ds_read_b64_tr_b16 v[36:37], v9 offset:4096
    ds_read_b64_tr_b16 v[38:39], v9 offset:4608
    ds_read_b64_tr_b16 v[40:41], v10 offset:4096
    ds_read_b64_tr_b16 v[42:43], v10 offset:4608
    ds_read_b64_tr_b16 v[44:45], v11 offset:4096
    ds_read_b64_tr_b16 v[46:47], v11 offset:4608
    s_waitcnt lgkmcnt(8)
    s_add_u32 m0, s25, 0
    s_nop 0
    buffer_load_dwordx4 v2, s[12:15], s26 offen offset:0 lds
    buffer_load_dwordx4 v3, s[12:15], s26 offen offset:1024 lds
    buffer_load_dwordx4 v4, s[12:15], s26 offen offset:2048 lds
    buffer_load_dwordx4 v5, s[12:15], s26 offen offset:3072 lds
    s_add_u32 s26, s26, 65536
    s_and_b32 s26, s26, 2097151
    v_mfma_f32_16x16x32_bf16 v[48:51], v[16:19], v[96:99], v[48:51]
    v_mfma_f32_16x16x32_bf16 v[52:55], v[20:23], v[96:99], v[52:55]
    v_mfma_f32_16x16x32_bf16 v[56:59], v[24:27], v[96:99], v[56:59]
    v_mfma_f32_16x16x32_bf16 v[60:63], v[28:31], v[96:99], v[60:63]
    v_mfma_f32_16x16x32_bf16 v[64:67], v[16:19], v[100:103], v[64:67]
    v_mfma_f32_16x16x32_bf16 v[68:71], v[20:23], v[100:103], v[68:71]
    v_mfma_f32_16x16x32_bf16 v[72:75], v[24:27], v[100:103], v[72:75]
    v_mfma_f32_16x16x32_bf16 v[76:79], v[28:31], v[100:103], v[76:79]
    v_mfma_f32_16x16x32_bf16 v[80:83], v[16:19], v[104:107], v[80:83]
    v_mfma_f32_16x16x32_bf16 v[84:87], v[20:23], v[104:107], v[84:87]
    v_mfma_f32_16x16x32_bf16 v[88:91], v[24:27], v[104:107], v[88:91]
    v_mfma_f32_16x16x32_bf16 v[92:95], v[28:31], v[104:107], v[92:95]
    buffer_load_dwordx4 v[96:99], v6, s[16:19], s27 offen offset:0
    buffer_load_dwordx4 v[100:103], v6, s[16:19], s27 offen offset:1024
    buffer_load_dwordx4 v[104:107], v6, s[16:19], s27 offen offset:2048
    s_add_u32 s27, s27, 3072
    s_cmp_eq_u32 s27, 98304
    s_cselect_b32 s27, 0, s27
    s_waitcnt vmcnt(42)
    ds_read_b64_tr_b16 v[16:17], v8 offset:8192
    ds_read_b64_tr_b16 v[18:19], v8 offset:8704
    ds_read_b64_tr_b16 v[20:21], v9 offset:8192
    ds_read_b64_tr_b16 v[22:23], v9 offset:8704
    ds_read_b64_tr_b16 v[24:25], v10 offset:8192
    ds_read_b64_tr_b16 v[26:27], v10 offset:8704
    ds_read_b64_tr_b16 v[28:29], v11 offset:8192
    ds_read_b64_tr_b16 v[30:31], v11 offset:8704
    s_waitcnt lgkmcnt(8)
    s_add_u32 m0, s25, 4096
    s_nop 0
    buffer_load_dwordx4 v2, s[12:15], s26 offen offset:0 lds
    buffer_load_dwordx4 v3, s[12:15], s26 offen offset:1024 lds
    buffer_load_dwordx4 v4, s[12:15], s26 offen offset:2048 lds
    buffer_load_dwordx4 v5, s[12:15], s26 offen offset:3072 lds
    s_add_u32 s26, s26, 65536
    s_and_b32 s26, s26, 2097151
    v_mfma_f32_16x16x32_bf16 v[48:51], v[32:35], v[108:111], v[48:51]
    v_mfma_f32_16x16x32_bf16 v[52:55], v[36:39], v[108:111], v[52:55]
    v_mfma_f32_16x16x32_bf16 v[56:59], v[40:43], v[108:111], v[56:59]
    v_mfma_f32_16x16x32_bf16 v[60:63], v[44:47], v[108:111], v[60:63]
    v_mfma_f32_16x16x32_bf16 v[64:67], v[32:35], v[112:115], v[64:67]
    v_mfma_f32_16x16x32_bf16 v[68:71], v[36:39], v[112:115], v[68:71]
    v_mfma_f32_16x16x32_bf16 v[72:75], v[40:43], v[112:115], v[72:75]
    v_mfma_f32_16x16x32_bf16 v[76:79], v[44:47], v[112:115], v[76:79]
    v_mfma_f32_16x16x32_bf16 v[80:83], v[32:35], v[116:119], v[80:83]
    v_mfma_f32_16x16x32_bf16 v[84:87], v[36:39], v[116:119], v[84:87]
    v_mfma_f32_16x16x32_bf16 v[88:91], v[40:43], v[116:119], v[88:91]
    v_mfma_f32_16x16x32_bf16 v[92:95], v[44:47], v[116:119], v[92:95]
    buffer_load_dwordx4 v[108:111], v6, s[16:19], s27 offen offset:0
    buffer_load_dwordx4 v[112:115], v6, s[16:19], s27 offen offset:1024
    buffer_load_dwordx4 v[116:119], v6, s[16:19], s27 offen offset:2048
    s_add_u32 s27, s27, 3072
    s_cmp_eq_u32 s27, 98304
    s_cselect_b32 s27, 0, s27
    s_waitcnt vmcnt(42)
    ds_read_b64_tr_b16 v[32:33], v8 offset:12288
    ds_read_b64_tr_b16 v[34:35], v8 offset:12800
    ds_read_b64_tr_b16 v[36:37], v9 offset:12288
    ds_read_b64_tr_b16 v[38:39], v9 offset:12800
    ds_read_b64_tr_b16 v[40:41], v10 offset:12288
    ds_read_b64_tr_b16 v[42:43], v10 offset:12800
    ds_read_b64_tr_b16 v[44:45], v11 offset:12288
    ds_read_b64_tr_b16 v[46:47], v11 offset:12800
    s_waitcnt lgkmcnt(8)
    s_add_u32 m0, s25, 8192
    s_nop 0
    buffer_load_dwordx4 v2, s[12:15], s26 offen offset:0 lds
    buffer_load_dwordx4 v3, s[12:15], s26 offen offset:1024 lds
    buffer_load_dwordx4 v4, s[12:15], s26 offen offset:2048 lds
    buffer_load_dwordx4 v5, s[12:15], s26 offen offset:3072 lds
    s_add_u32 s26, s26, 65536
    s_and_b32 s26, s26, 2097151
    v_mfma_f32_16x16x32_bf16 v[48:51], v[16:19], v[120:123], v[48:51]
    v_mfma_f32_16x16x32_bf16 v[52:55], v[20:23], v[120:123], v[52:55]
    v_mfma_f32_16x16x32_bf16 v[56:59], v[24:27], v[120:123], v[56:59]
    v_mfma_f32_16x16x32_bf16 v[60:63], v[28:31], v[120:123], v[60:63]
    v_mfma_f32_16x16x32_bf16 v[64:67], v[16:19], v[124:127], v[64:67]
    v_mfma_f32_16x16x32_bf16 v[68:71], v[20:23], v[124:127], v[68:71]
    v_mfma_f32_16x16x32_bf16 v[72:75], v[24:27], v[124:127], v[72:75]
    v_mfma_f32_16x16x32_bf16 v[76:79], v[28:31], v[124:127], v[76:79]
    v_mfma_f32_16x16x32_bf16 v[80:83], v[16:19], v[128:131], v[80:83]
    v_mfma_f32_16x16x32_bf16 v[84:87], v[20:23], v[128:131], v[84:87]
    v_mfma_f32_16x16x32_bf16 v[88:91], v[24:27], v[128:131], v[88:91]
    v_mfma_f32_16x16x32_bf16 v[92:95], v[28:31], v[128:131], v[92:95]
    buffer_load_dwordx4 v[120:123], v6, s[16:19], s27 offen offset:0
    buffer_load_dwordx4 v[124:127], v6, s[16:19], s27 offen offset:1024
    buffer_load_dwordx4 v[128:131], v6, s[16:19], s27 offen offset:2048
    s_add_u32 s27, s27, 3072
    s_cmp_eq_u32 s27, 98304
    s_cselect_b32 s27, 0, s27
    s_waitcnt vmcnt(42)
    ds_read_b64_tr_b16 v[16:17], v8 offset:16384
    ds_read_b64_tr_b16 v[18:19], v8 offset:16896
    ds_read_b64_tr_b16 v[20:21], v9 offset:16384
    ds_read_b64_tr_b16 v[22:23], v9 offset:16896
    ds_read_b64_tr_b16 v[24:25], v10 offset:16384
    ds_read_b64_tr_b16 v[26:27], v10 offset:16896
    ds_read_b64_tr_b16 v[28:29], v11 offset:16384
    ds_read_b64_tr_b16 v[30:31], v11 offset:16896
    s_waitcnt lgkmcnt(8)
    s_add_u32 m0, s25, 12288
    s_nop 0
    buffer_load_dwordx4 v2, s[12:15], s26 offen offset:0 lds
    buffer_load_dwordx4 v3, s[12:15], s26 offen offset:1024 lds
    buffer_load_dwordx4 v4, s[12:15], s26 offen offset:2048 lds
    buffer_load_dwordx4 v5, s[12:15], s26 offen offset:3072 lds
    s_add_u32 s26, s26, 65536
    s_and_b32 s26, s26, 2097151
    v_mfma_f32_16x16x32_bf16 v[48:51], v[32:35], v[132:135], v[48:51]
    v_mfma_f32_16x16x32_bf16 v[52:55], v[36:39], v[132:135], v[52:55]
    v_mfma_f32_16x16x32_bf16 v[56:59], v[40:43], v[132:135], v[56:59]
    v_mfma_f32_16x16x32_bf16 v[60:63], v[44:47], v[132:135], v[60:63]
    v_mfma_f32_16x16x32_bf16 v[64:67], v[32:35], v[136:139], v[64:67]
    v_mfma_f32_16x16x32_bf16 v[68:71], v[36:39], v[136:139], v[68:71]
    v_mfma_f32_16x16x32_bf16 v[72:75], v[40:43], v[136:139], v[72:75]
    v_mfma_f32_16x16x32_bf16 v[76:79], v[44:47], v[136:139], v[76:79]
    v_mfma_f32_16x16x32_bf16 v[80:83], v[32:35], v[140:143], v[80:83]
    v_mfma_f32_16x16x32_bf16 v[84:87], v[36:39], v[140:143], v[84:87]
    v_mfma_f32_16x16x32_bf16 v[88:91], v[40:43], v[140:143], v[88:91]
    v_mfma_f32_16x16x32_bf16 v[92:95], v[44:47], v[140:143], v[92:95]
    buffer_load_dwordx4 v[132:135], v6, s[16:19], s27 offen offset:0
    buffer_load_dwordx4 v[136:139], v6, s[16:19], s27 offen offset:1024
    buffer_load_dwordx4 v[140:143], v6, s[16:19], s27 offen offset:2048
    s_add_u32 s27, s27, 3072
    s_cmp_eq_u32 s27, 98304
    s_cselect_b32 s27, 0, s27
    s_waitcnt vmcnt(42)
    ds_read_b64_tr_b16 v[32:33], v8 offset:20480
    ds_read_b64_tr_b16 v[34:35], v8 offset:20992
    ds_read_b64_tr_b16 v[36:37], v9 offset:20480
    ds_read_b64_tr_b16 v[38:39], v9 offset:20992
    ds_read_b64_tr_b16 v[40:41], v10 offset:20480
    ds_read_b64_tr_b16 v[42:43], v10 offset:20992
    ds_read_b64_tr_b16 v[44:45], v11 offset:20480
    ds_read_b64_tr_b16 v[46:47], v11 offset:20992
    s_waitcnt lgkmcnt(8)
    s_add_u32 m0, s25, 16384
    s_nop 0
    buffer_load_dwordx4 v2, s[12:15], s26 offen offset:0 lds
    buffer_load_dwordx4 v3, s[12:15], s26 offen offset:1024 lds
    buffer_load_dwordx4 v4, s[12:15], s26 offen offset:2048 lds
    buffer_load_dwordx4 v5, s[12:15], s26 offen offset:3072 lds
    s_add_u32 s26, s26, 65536
    s_and_b32 s26, s26, 2097151
    v_mfma_f32_16x16x32_bf16 v[48:51], v[16:19], v[144:147], v[48:51]
    v_mfma_f32_16x16x32_bf16 v[52:55], v[20:23], v[144:147], v[52:55]
    v_mfma_f32_16x16x32_bf16 v[56:59], v[24:27], v[144:147], v[56:59]
    v_mfma_f32_16x16x32_bf16 v[60:63], v[28:31], v[144:147], v[60:63]
    v_mfma_f32_16x16x32_bf16 v[64:67], v[16:19], v[148:151], v[64:67]
    v_mfma_f32_16x16x32_bf16 v[68:71], v[20:23], v[148:151], v[68:71]
    v_mfma_f32_16x16x32_bf16 v[72:75], v[24:27], v[148:151], v[72:75]
    v_mfma_f32_16x16x32_bf16 v[76:79], v[28:31], v[148:151], v[76:79]
    v_mfma_f32_16x16x32_bf16 v[80:83], v[16:19], v[152:155], v[80:83]
    v_mfma_f32_16x16x32_bf16 v[84:87], v[20:23], v[152:155], v[84:87]
    v_mfma_f32_16x16x32_bf16 v[88:91], v[24:27], v[152:155], v[88:91]
    v_mfma_f32_16x16x32_bf16 v[92:95], v[28:31], v[152:155], v[92:95]
    buffer_load_dwordx4 v[144:147], v6, s[16:19], s27 offen offset:0
    buffer_load_dwordx4 v[148:151], v6, s[16:19], s27 offen offset:1024
    buffer_load_dwordx4 v[152:155], v6, s[16:19], s27 offen offset:2048
    s_add_u32 s27, s27, 3072
    s_cmp_eq_u32 s27, 98304
    s_cselect_b32 s27, 0, s27
    s_waitcnt vmcnt(42)
    ds_read_b64_tr_b16 v[16:17], v8 offset:24576
    ds_read_b64_tr_b16 v[18:19], v8 offset:25088
    ds_read_b64_tr_b16 v[20:21], v9 offset:24576
    ds_read_b64_tr_b16 v[22:23], v9 offset:25088
    ds_read_b64_tr_b16 v[24:25], v10 offset:24576
    ds_read_b64_tr_b16 v[26:27], v10 offset:25088
    ds_read_b64_tr_b16 v[28:29], v11 offset:24576
    ds_read_b64_tr_b16 v[30:31], v11 offset:25088
    s_waitcnt lgkmcnt(8)
    s_add_u32 m0, s25, 20480
    s_nop 0
    buffer_load_dwordx4 v2, s[12:15], s26 offen offset:0 lds
    buffer_load_dwordx4 v3, s[12:15], s26 offen offset:1024 lds
    buffer_load_dwordx4 v4, s[12:15], s26 offen offset:2048 lds
    buffer_load_dwordx4 v5, s[12:15], s26 offen offset:3072 lds
    s_add_u32 s26, s26, 65536
    s_and_b32 s26, s26, 2097151
    v_mfma_f32_16x16x32_bf16 v[48:51], v[32:35], v[156:159], v[48:51]
    v_mfma_f32_16x16x32_bf16 v[52:55], v[36:39], v[156:159], v[52:55]
    v_mfma_f32_16x16x32_bf16 v[56:59], v[40:43], v[156:159], v[56:59]
    v_mfma_f32_16x16x32_bf16 v[60:63], v[44:47], v[156:159], v[60:63]
    v_mfma_f32_16x16x32_bf16 v[64:67], v[32:35], v[160:163], v[64:67]
    v_mfma_f32_16x16x32_bf16 v[68:71], v[36:39], v[160:163], v[68:71]
    v_mfma_f32_16x16x32_bf16 v[72:75], v[40:43], v[160:163], v[72:75]
    v_mfma_f32_16x16x32_bf16 v[76:79], v[44:47], v[160:163], v[76:79]
    v_mfma_f32_16x16x32_bf16 v[80:83], v[32:35], v[164:167], v[80:83]
    v_mfma_f32_16x16x32_bf16 v[84:87], v[36:39], v[164:167], v[84:87]
    v_mfma_f32_16x16x32_bf16 v[88:91], v[40:43], v[164:167], v[88:91]
    v_mfma_f32_16x16x32_bf16 v[92:95], v[44:47], v[164:167], v[92:95]
    buffer_load_dwordx4 v[156:159], v6, s[16:19], s27 offen offset:0
    buffer_load_dwordx4 v[160:163], v6, s[16:19], s27 offen offset:1024
    buffer_load_dwordx4 v[164:167], v6, s[16:19], s27 offen offset:2048
    s_add_u32 s27, s27, 3072
    s_cmp_eq_u32 s27, 98304
    s_cselect_b32 s27, 0, s27
    s_waitcnt vmcnt(42)
    ds_read_b64_tr_b16 v[32:33], v8 offset:28672
    ds_read_b64_tr_b16 v[34:35], v8 offset:29184
    ds_read_b64_tr_b16 v[36:37], v9 offset:28672
    ds_read_b64_tr_b16 v[38:39], v9 offset:29184
    ds_read_b64_tr_b16 v[40:41], v10 offset:28672
    ds_read_b64_tr_b16 v[42:43], v10 offset:29184
    ds_read_b64_tr_b16 v[44:45], v11 offset:28672
    ds_read_b64_tr_b16 v[46:47], v11 offset:29184
    s_waitcnt lgkmcnt(8)
    s_add_u32 m0, s25, 24576
    s_nop 0
    buffer_load_dwordx4 v2, s[12:15], s26 offen offset:0 lds
    buffer_load_dwordx4 v3, s[12:15], s26 offen offset:1024 lds
    buffer_load_dwordx4 v4, s[12:15], s26 offen offset:2048 lds
    buffer_load_dwordx4 v5, s[12:15], s26 offen offset:3072 lds
    s_add_u32 s26, s26, 65536
    s_and_b32 s26, s26, 2097151
    v_mfma_f32_16x16x32_bf16 v[48:51], v[16:19], v[168:171], v[48:51]
    v_mfma_f32_16x16x32_bf16 v[52:55], v[20:23], v[168:171], v[52:55]
    v_mfma_f32_16x16x32_bf16 v[56:59], v[24:27], v[168:171], v[56:59]
    v_mfma_f32_16x16x32_bf16 v[60:63], v[28:31], v[168:171], v[60:63]
    v_mfma_f32_16x16x32_bf16 v[64:67], v[16:19], v[172:175], v[64:67]
    v_mfma_f32_16x16x32_bf16 v[68:71], v[20:23], v[172:175], v[68:71]
    v_mfma_f32_16x16x32_bf16 v[72:75], v[24:27], v[172:175], v[72:75]
    v_mfma_f32_16x16x32_bf16 v[76:79], v[28:31], v[172:175], v[76:79]
    v_mfma_f32_16x16x32_bf16 v[80:83], v[16:19], v[176:179], v[80:83]
    v_mfma_f32_16x16x32_bf16 v[84:87], v[20:23], v[176:179], v[84:87]
    v_mfma_f32_16x16x32_bf16 v[88:91], v[24:27], v[176:179], v[88:91]
    v_mfma_f32_16x16x32_bf16 v[92:95], v[28:31], v[176:179], v[92:95]
    buffer_load_dwordx4 v[168:171], v6, s[16:19], s27 offen offset:0
    buffer_load_dwordx4 v[172:175], v6, s[16:19], s27 offen offset:1024
    buffer_load_dwordx4 v[176:179], v6, s[16:19], s27 offen offset:2048
    s_add_u32 s27, s27, 3072
    s_cmp_eq_u32 s27, 98304
    s_cselect_b32 s27, 0, s27
    s_waitcnt vmcnt(42)
    ds_read_b64_tr_b16 v[16:17], v8 offset:0
    ds_read_b64_tr_b16 v[18:19], v8 offset:512
    ds_read_b64_tr_b16 v[20:21], v9 offset:0
    ds_read_b64_tr_b16 v[22:23], v9 offset:512
    ds_read_b64_tr_b16 v[24:25], v10 offset:0
    ds_read_b64_tr_b16 v[26:27], v10 offset:512
    ds_read_b64_tr_b16 v[28:29], v11 offset:0
    ds_read_b64_tr_b16 v[30:31], v11 offset:512
    s_waitcnt lgkmcnt(8)
    s_add_u32 m0, s25, 28672
    s_nop 0
    buffer_load_dwordx4 v2, s[12:15], s26 offen offset:0 lds
    buffer_load_dwordx4 v3, s[12:15], s26 offen offset:1024 lds
    buffer_load_dwordx4 v4, s[12:15], s26 offen offset:2048 lds
    buffer_load_dwordx4 v5, s[12:15], s26 offen offset:3072 lds
    s_add_u32 s26, s26, 65536
    s_and_b32 s26, s26, 2097151
    v_mfma_f32_16x16x32_bf16 v[48:51], v[32:35], v[180:183], v[48:51]
    v_mfma_f32_16x16x32_bf16 v[52:55], v[36:39], v[180:183], v[52:55]
    v_mfma_f32_16x16x32_bf16 v[56:59], v[40:43], v[180:183], v[56:59]
    v_mfma_f32_16x16x32_bf16 v[60:63], v[44:47], v[180:183], v[60:63]
    v_mfma_f32_16x16x32_bf16 v[64:67], v[32:35], v[184:187], v[64:67]
    v_mfma_f32_16x16x32_bf16 v[68:71], v[36:39], v[184:187], v[68:71]
    v_mfma_f32_16x16x32_bf16 v[72:75], v[40:43], v[184:187], v[72:75]
    v_mfma_f32_16x16x32_bf16 v[76:79], v[44:47], v[184:187], v[76:79]
    v_mfma_f32_16x16x32_bf16 v[80:83], v[32:35], v[188:191], v[80:83]
    v_mfma_f32_16x16x32_bf16 v[84:87], v[36:39], v[188:191], v[84:87]
    v_mfma_f32_16x16x32_bf16 v[88:91], v[40:43], v[188:191], v[88:91]
    v_mfma_f32_16x16x32_bf16 v[92:95], v[44:47], v[188:191], v[92:95]
    buffer_load_dwordx4 v[180:183], v6, s[16:19], s27 offen offset:0
    buffer_load_dwordx4 v[184:187], v6, s[16:19], s27 offen offset:1024
    buffer_load_dwordx4 v[188:191], v6, s[16:19], s27 offen offset:2048
    s_add_u32 s27, s27, 3072
    s_cmp_eq_u32 s27, 98304
    s_cselect_b32 s27, 0, s27
    s_sub_u32 s28, s28, 1
    s_cmp_lg_u32 s28, 0
    s_cbranch_scc1 L_k2loop_2
    s_waitcnt vmcnt(42)
    ds_read_b64_tr_b16 v[32:33], v8 offset:4096
    ds_read_b64_tr_b16 v[34:35], v8 offset:4608
    ds_read_b64_tr_b16 v[36:37], v9 offset:4096
    ds_read_b64_tr_b16 v[38:39], v9 offset:4608
    ds_read_b64_tr_b16 v[40:41], v10 offset:4096
    ds_read_b64_tr_b16 v[42:43], v10 offset:4608
    ds_read_b64_tr_b16 v[44:45], v11 offset:4096
    ds_read_b64_tr_b16 v[46:47], v11 offset:4608
    s_waitcnt lgkmcnt(8)
    v_mfma_f32_16x16x32_bf16 v[48:51], v[16:19], v[96:99], v[48:51]
    v_mfma_f32_16x16x32_bf16 v[52:55], v[20:23], v[96:99], v[52:55]
    v_mfma_f32_16x16x32_bf16 v[56:59], v[24:27], v[96:99], v[56:59]
    v_mfma_f32_16x16x32_bf16 v[60:63], v[28:31], v[96:99], v[60:63]
    v_mfma_f32_16x16x32_bf16 v[64:67], v[16:19], v[100:103], v[64:67]
    v_mfma_f32_16x16x32_bf16 v[68:71], v[20:23], v[100:103], v[68:71]
    v_mfma_f32_16x16x32_bf16 v[72:75], v[24:27], v[100:103], v[72:75]
    v_mfma_f32_16x16x32_bf16 v[76:79], v[28:31], v[100:103], v[76:79]
    v_mfma_f32_16x16x32_bf16 v[80:83], v[16:19], v[104:107], v[80:83]
    v_mfma_f32_16x16x32_bf16 v[84:87], v[20:23], v[104:107], v[84:87]
    v_mfma_f32_16x16x32_bf16 v[88:91], v[24:27], v[104:107], v[88:91]
    v_mfma_f32_16x16x32_bf16 v[92:95], v[28:31], v[104:107], v[92:95]
    s_waitcnt vmcnt(35)
    ds_read_b64_tr_b16 v[16:17], v8 offset:8192
    ds_read_b64_tr_b16 v[18:19], v8 offset:8704
    ds_read_b64_tr_b16 v[20:21], v9 offset:8192
    ds_read_b64_tr_b16 v[22:23], v9 offset:8704
    ds_read_b64_tr_b16 v[24:25], v10 offset:8192
    ds_read_b64_tr_b16 v[26:27], v10 offset:8704
    ds_read_b64_tr_b16 v[28:29], v11 offset:8192
    ds_read_b64_tr_b16 v[30:31], v11 offset:8704
    s_waitcnt lgkmcnt(8)
    v_mfma_f32_16x16x32_bf16 v[48:51], v[32:35], v[108:111], v[48:51]
    v_mfma_f32_16x16x32_bf16 v[52:55], v[36:39], v[108:111], v[52:55]
    v_mfma_f32_16x16x32_bf16 v[56:59], v[40:43], v[108:111], v[56:59]
    v_mfma_f32_16x16x32_bf16 v[60:63], v[44:47], v[108:111], v[60:63]
    v_mfma_f32_16x16x32_bf16 v[64:67], v[32:35], v[112:115], v[64:67]
    v_mfma_f32_16x16x32_bf16 v[68:71], v[36:39], v[112:115], v[68:71]
    v_mfma_f32_16x16x32_bf16 v[72:75], v[40:43], v[112:115], v[72:75]
    v_mfma_f32_16x16x32_bf16 v[76:79], v[44:47], v[112:115], v[76:79]
    v_mfma_f32_16x16x32_bf16 v[80:83], v[32:35], v[116:119], v[80:83]
    v_mfma_f32_16x16x32_bf16 v[84:87], v[36:39], v[116:119], v[84:87]
    v_mfma_f32_16x16x32_bf16 v[88:91], v[40:43], v[116:119], v[88:91]
    v_mfma_f32_16x16x32_bf16 v[92:95], v[44:47], v[116:119], v[92:95]
    s_waitcnt vmcnt(28)
    ds_read_b64_tr_b16 v[32:33], v8 offset:12288
    ds_read_b64_tr_b16 v[34:35], v8 offset:12800
    ds_read_b64_tr_b16 v[36:37], v9 offset:12288
    ds_read_b64_tr_b16 v[38:39], v9 offset:12800
    ds_read_b64_tr_b16 v[40:41], v10 offset:12288
    ds_read_b64_tr_b16 v[42:43], v10 offset:12800
    ds_read_b64_tr_b16 v[44:45], v11 offset:12288
    ds_read_b64_tr_b16 v[46:47], v11 offset:12800
    s_waitcnt lgkmcnt(8)
    v_mfma_f32_16x16x32_bf16 v[48:51], v[16:19], v[120:123], v[48:51]
    v_mfma_f32_16x16x32_bf16 v[52:55], v[20:23], v[120:123], v[52:55]
    v_mfma_f32_16x16x32_bf16 v[56:59], v[24:27], v[120:123], v[56:59]
    v_mfma_f32_16x16x32_bf16 v[60:63], v[28:31], v[120:123], v[60:63]
    v_mfma_f32_16x16x32_bf16 v[64:67], v[16:19], v[124:127], v[64:67]
    v_mfma_f32_16x16x32_bf16 v[68:71], v[20:23], v[124:127], v[68:71]
    v_mfma_f32_16x16x32_bf16 v[72:75], v[24:27], v[124:127], v[72:75]
    v_mfma_f32_16x16x32_bf16 v[76:79], v[28:31], v[124:127], v[76:79]
    v_mfma_f32_16x16x32_bf16 v[80:83], v[16:19], v[128:131], v[80:83]
    v_mfma_f32_16x16x32_bf16 v[84:87], v[20:23], v[128:131], v[84:87]
    v_mfma_f32_16x16x32_bf16 v[88:91], v[24:27], v[128:131], v[88:91]
    v_mfma_f32_16x16x32_bf16 v[92:95], v[28:31], v[128:131], v[92:95]
    s_waitcnt vmcnt(21)
    ds_read_b64_tr_b16 v[16:17], v8 offset:16384
    ds_read_b64_tr_b16 v[18:19], v8 offset:16896
    ds_read_b64_tr_b16 v[20:21], v9 offset:16384
    ds_read_b64_tr_b16 v[22:23], v9 offset:16896
    ds_read_b64_tr_b16 v[24:25], v10 offset:16384
    ds_read_b64_tr_b16 v[26:27], v10 offset:16896
    ds_read_b64_tr_b16 v[28:29], v11 offset:16384
    ds_read_b64_tr_b16 v[30:31], v11 offset:16896
    s_waitcnt lgkmcnt(8)
    v_mfma_f32_16x16x32_bf16 v[48:51], v[32:35], v[132:135], v[48:51]
    v_mfma_f32_16x16x32_bf16 v[52:55], v[36:39], v[132:135], v[52:55]
    v_mfma_f32_16x16x32_bf16 v[56:59], v[40:43], v[132:135], v[56:59]
    v_mfma_f32_16x16x32_bf16 v[60:63], v[44:47], v[132:135], v[60:63]
    v_mfma_f32_16x16x32_bf16 v[64:67], v[32:35], v[136:139], v[64:67]
    v_mfma_f32_16x16x32_bf16 v[68:71], v[36:39], v[136:139], v[68:71]
    v_mfma_f32_16x16x32_bf16 v[72:75], v[40:43], v[136:139], v[72:75]
    v_mfma_f32_16x16x32_bf16 v[76:79], v[44:47], v[136:139], v[76:79]
    v_mfma_f32_16x16x32_bf16 v[80:83], v[32:35], v[140:143], v[80:83]
    v_mfma_f32_16x16x32_bf16 v[84:87], v[36:39], v[140:143], v[84:87]
    v_mfma_f32_16x16x32_bf16 v[88:91], v[40:43], v[140:143], v[88:91]
    v_mfma_f32_16x16x32_bf16 v[92:95], v[44:47], v[140:143], v[92:95]
    s_waitcnt vmcnt(14)
    ds_read_b64_tr_b16 v[32:33], v8 offset:20480
    ds_read_b64_tr_b16 v[34:35], v8 offset:20992
    ds_read_b64_tr_b16 v[36:37], v9 offset:20480
    ds_read_b64_tr_b16 v[38:39], v9 offset:20992
    ds_read_b64_tr_b16 v[40:41], v10 offset:20480
    ds_read_b64_tr_b16 v[42:43], v10 offset:20992
    ds_read_b64_tr_b16 v[44:45], v11 offset:20480
    ds_read_b64_tr_b16 v[46:47], v11 offset:20992
    s_waitcnt lgkmcnt(8)
    v_mfma_f32_16x16x32_bf16 v[48:51], v[16:19], v[144:147], v[48:51]
    v_mfma_f32_16x16x32_bf16 v[52:55], v[20:23], v[144:147], v[52:55]
    v_mfma_f32_16x16x32_bf16 v[56:59], v[24:27], v[144:147], v[56:59]
    v_mfma_f32_16x16x32_bf16 v[60:63], v[28:31], v[144:147], v[60:63]
    v_mfma_f32_16x16x32_bf16 v[64:67], v[16:19], v[148:151], v[64:67]
    v_mfma_f32_16x16x32_bf16 v[68:71], v[20:23], v[148:151], v[68:71]
    v_mfma_f32_16x16x32_bf16 v[72:75], v[24:27], v[148:151], v[72:75]
    v_mfma_f32_16x16x32_bf16 v[76:79], v[28:31], v[148:151], v[76:79]
    v_mfma_f32_16x16x32_bf16 v[80:83], v[16:19], v[152:155], v[80:83]
    v_mfma_f32_16x16x32_bf16 v[84:87], v[20:23], v[152:155], v[84:87]
    v_mfma_f32_16x16x32_bf16 v[88:91], v[24:27], v[152:155], v[88:91]
    v_mfma_f32_16x16x32_bf16 v[92:95], v[28:31], v[152:155], v[92:95]
    s_waitcnt vmcnt(7)
    ds_read_b64_tr_b16 v[16:17], v8 offset:24576
    ds_read_b64_tr_b16 v[18:19], v8 offset:25088
    ds_read_b64_tr_b16 v[20:21], v9 offset:24576
    ds_read_b64_tr_b16 v[22:23], v9 offset:25088
    ds_read_b64_tr_b16 v[24:25], v10 offset:24576
    ds_read_b64_tr_b16 v[26:27], v10 offset:25088
    ds_read_b64_tr_b16 v[28:29], v11 offset:24576
    ds_read_b64_tr_b16 v[30:31], v11 offset:25088
    s_waitcnt lgkmcnt(8)
    v_mfma_f32_16x16x32_bf16 v[48:51], v[32:35], v[156:159], v[48:51]
    v_mfma_f32_16x16x32_bf16 v[52:55], v[36:39], v[156:159], v[52:55]
    v_mfma_f32_16x16x32_bf16 v[56:59], v[40:43], v[156:159], v[56:59]
    v_mfma_f32_16x16x32_bf16 v[60:63], v[44:47], v[156:159], v[60:63]
    v_mfma_f32_16x16x32_bf16 v[64:67], v[32:35], v[160:163], v[64:67]
    v_mfma_f32_16x16x32_bf16 v[68:71], v[36:39], v[160:163], v[68:71]
    v_mfma_f32_16x16x32_bf16 v[72:75], v[40:43], v[160:163], v[72:75]
    v_mfma_f32_16x16x32_bf16 v[76:79], v[44:47], v[160:163], v[76:79]
    v_mfma_f32_16x16x32_bf16 v[80:83], v[32:35], v[164:167], v[80:83]
    v_mfma_f32_16x16x32_bf16 v[84:87], v[36:39], v[164:167], v[84:87]
    v_mfma_f32_16x16x32_bf16 v[88:91], v[40:43], v[164:167], v[88:91]
    v_mfma_f32_16x16x32_bf16 v[92:95], v[44:47], v[164:167], v[92:95]
    s_waitcnt vmcnt(0)
    ds_read_b64_tr_b16 v[32:33], v8 offset:28672
    ds_read_b64_tr_b16 v[34:35], v8 offset:29184
    ds_read_b64_tr_b16 v[36:37], v9 offset:28672
    ds_read_b64_tr_b16 v[38:39], v9 offset:29184
    ds_read_b64_tr_b16 v[40:41], v10 offset:28672
    ds_read_b64_tr_b16 v[42:43], v10 offset:29184
    ds_read_b64_tr_b16 v[44:45], v11 offset:28672
    ds_read_b64_tr_b16 v[46:47], v11 offset:29184
    s_waitcnt lgkmcnt(8)
    v_mfma_f32_16x16x32_bf16 v[48:51], v[16:19], v[168:171], v[48:51]
    v_mfma_f32_16x16x32_bf16 v[52:55], v[20:23], v[168:171], v[52:55]
    v_mfma_f32_16x16x32_bf16 v[56:59], v[24:27], v[168:171], v[56:59]
    v_mfma_f32_16x16x32_bf16 v[60:63], v[28:31], v[168:171], v[60:63]
    v_mfma_f32_16x16x32_bf16 v[64:67], v[16:19], v[172:175], v[64:67]
    v_mfma_f32_16x16x32_bf16 v[68:71], v[20:23], v[172:175], v[68:71]
    v_mfma_f32_16x16x32_bf16 v[72:75], v[24:27], v[172:175], v[72:75]
    v_mfma_f32_16x16x32_bf16 v[76:79], v[28:31], v[172:175], v[76:79]
    v_mfma_f32_16x16x32_bf16 v[80:83], v[16:19], v[176:179], v[80:83]
    v_mfma_f32_16x16x32_bf16 v[84:87], v[20:23], v[176:179], v[84:87]
    v_mfma_f32_16x16x32_bf16 v[88:91], v[24:27], v[176:179], v[88:91]
    v_mfma_f32_16x16x32_bf16 v[92:95], v[28:31], v[176:179], v[92:95]
    s_waitcnt lgkmcnt(0)
    v_mfma_f32_16x16x32_bf16 v[48:51], v[32:35], v[180:183], v[48:51]
    v_mfma_f32_16x16x32_bf16 v[52:55], v[36:39], v[180:183], v[52:55]
    v_mfma_f32_16x16x32_bf16 v[56:59], v[40:43], v[180:183], v[56:59]
    v_mfma_f32_16x16x32_bf16 v[60:63], v[44:47], v[180:183], v[60:63]
    v_mfma_f32_16x16x32_bf16 v[64:67], v[32:35], v[184:187], v[64:67]
    v_mfma_f32_16x16x32_bf16 v[68:71], v[36:39], v[184:187], v[68:71]
    v_mfma_f32_16x16x32_bf16 v[72:75], v[40:43], v[184:187], v[72:75]
    v_mfma_f32_16x16x32_bf16 v[76:79], v[44:47], v[184:187], v[76:79]
    v_mfma_f32_16x16x32_bf16 v[80:83], v[32:35], v[188:191], v[80:83]
    v_mfma_f32_16x16x32_bf16 v[84:87], v[36:39], v[188:191], v[84:87]
    v_mfma_f32_16x16x32_bf16 v[88:91], v[40:43], v[188:191], v[88:91]
    v_mfma_f32_16x16x32_bf16 v[92:95], v[44:47], v[188:191], v[92:95]
    s_nop 15
    s_barrier
    s_mul_i32 s36, s24, 12288
    v_add_u32 v12, s36, v6
    ds_write_b128 v12, v[48:51] offset:0
    ds_write_b128 v12, v[52:55] offset:1024
    ds_write_b128 v12, v[56:59] offset:2048
    ds_write_b128 v12, v[60:63] offset:3072
    ds_write_b128 v12, v[64:67] offset:4096
    ds_write_b128 v12, v[68:71] offset:5120
    ds_write_b128 v12, v[72:75] offset:6144
    ds_write_b128 v12, v[76:79] offset:7168
    ds_write_b128 v12, v[80:83] offset:8192
    ds_write_b128 v12, v[84:87] offset:9216
    ds_write_b128 v12, v[88:91] offset:10240
    ds_write_b128 v12, v[92:95] offset:11264
    s_waitcnt lgkmcnt(0)
    s_barrier
    s_lshl_b32 s36, s24, 10
    v_add_u32 v12, s36, v6
    ds_read_b128 v[96:99], v12 offset:0
    ds_read_b128 v[100:103], v12 offset:12288
    ds_read_b128 v[104:107], v12 offset:24576
    ds_read_b128 v[108:111], v12 offset:36864
    ds_read_b128 v[112:115], v12 offset:4096
    ds_read_b128 v[116:119], v12 offset:16384
    ds_read_b128 v[120:123], v12 offset:28672
    ds_read_b128 v[124:127], v12 offset:40960
    ds_read_b128 v[128:131], v12 offset:8192
    ds_read_b128 v[132:135], v12 offset:20480
    ds_read_b128 v[136:139], v12 offset:32768
    ds_read_b128 v[140:143], v12 offset:45056
    v_and_b32 v13, 15, v1
    v_lshlrev_b32 v13, 11, v13
    v_lshrrev_b32 v14, 4, v1
    v_lshl_add_u32 v13, v14, 3, v13
    s_mul_i32 s36, s29, 98304
    s_lshl_b32 s37, s30, 7
    s_add_u32 s36, s36, s37
    s_lshl_b32 s37, s24, 5
    s_add_u32 s36, s36, s37
    s_waitcnt lgkmcnt(8)
    v_add_f32 v96, v96, v100
    v_add_f32 v104, v104, v108
    v_add_f32 v97, v97, v101
    v_add_f32 v105, v105, v109
    v_add_f32 v98, v98, v102
    v_add_f32 v106, v106, v110
    v_add_f32 v99, v99, v103
    v_add_f32 v107, v107, v111
    v_add_f32 v96, v96, v104
    v_add_f32 v97, v97, v105
    v_add_f32 v98, v98, v106
    v_add_f32 v99, v99, v107
    v_cvt_pk_bf16_f32 v100, v96, v97
    v_cvt_pk_bf16_f32 v101, v98, v99
    buffer_store_dwordx2 v[100:101], v13, s[20:23], s36 offen
    s_add_u32 s36, s36, 32768
    s_waitcnt lgkmcnt(4)
    v_add_f32 v112, v112, v116
    v_add_f32 v120, v120, v124
    v_add_f32 v113, v113, v117
    v_add_f32 v121, v121, v125
    v_add_f32 v114, v114, v118
    v_add_f32 v122, v122, v126
    v_add_f32 v115, v115, v119
    v_add_f32 v123, v123, v127
    v_add_f32 v112, v112, v120
    v_add_f32 v113, v113, v121
    v_add_f32 v114, v114, v122
    v_add_f32 v115, v115, v123
    v_cvt_pk_bf16_f32 v116, v112, v113
    v_cvt_pk_bf16_f32 v117, v114, v115
    buffer_store_dwordx2 v[116:117], v13, s[20:23], s36 offen
    s_add_u32 s36, s36, 32768
    s_waitcnt lgkmcnt(0)
    v_add_f32 v128, v128, v132
    v_add_f32 v136, v136, v140
    v_add_f32 v129, v129, v133
    v_add_f32 v137, v137, v141
    v_add_f32 v130, v130, v134
    v_add_f32 v138, v138, v142
    v_add_f32 v131, v131, v135
    v_add_f32 v139, v139, v143
    v_add_f32 v128, v128, v136
    v_add_f32 v129, v129, v137
    v_add_f32 v130, v130, v138
    v_add_f32 v131, v131, v139
    v_cvt_pk_bf16_f32 v132, v128, v129
    v_cvt_pk_bf16_f32 v133, v130, v131
    buffer_store_dwordx2 v[132:133], v13, s[20:23], s36 offen
L_k2end_1:
    s_endpgm
.section .rodata,"a"
.p2align 6
.amdhsa_kernel attn_kernel
  .amdhsa_next_free_vgpr 348
  .amdhsa_next_free_sgpr 102
  .amdhsa_accum_offset 256
  .amdhsa_group_segment_fixed_size 0
  .amdhsa_kernarg_size 64
  .amdhsa_user_sgpr_count 2
  .amdhsa_user_sgpr_kernarg_segment_ptr 1
  .amdhsa_system_sgpr_workgroup_id_x 1
.end_amdhsa_kernel
.p2align 6
.amdhsa_kernel oproj_kernel
  .amdhsa_next_free_vgpr 192
  .amdhsa_next_free_sgpr 102
  .amdhsa_accum_offset 192
  .amdhsa_group_segment_fixed_size 0
  .amdhsa_kernarg_size 64
  .amdhsa_user_sgpr_count 2
  .amdhsa_user_sgpr_kernarg_segment_ptr 1
  .amdhsa_system_sgpr_workgroup_id_x 1
.end_amdhsa_kernel
```
